```python
import torch

def _softmax(x, axis=-1):
    return torch.softmax(x, dim=axis)
def _gelu(x):
    return torch.nn.functional.gelu(x, approximate="tanh")
def _silu(x):
    return torch.nn.functional.silu(x)
def _sigmoid(x):
    return torch.sigmoid(x)
def _layernorm(x, axis=-1, eps=1e-5):
    m = x.mean(dim=axis, keepdim=True)
    v = x.var(dim=axis, keepdim=True, unbiased=False)
    return (x - m) / torch.sqrt(v + eps)
def _scatter_add(tgt, idx, src, axis=0):
    return tgt.clone().index_add_(axis, idx, src)
def _segment_sum(src, seg, n):
    out = torch.zeros((n,) + src.shape[1:], dtype=src.dtype)
    return out.index_add_(0, seg, src)
def _pad(x, pw):
    flat = tuple(v for pair in reversed(pw) for v in pair)
    return torch.nn.functional.pad(x, flat)

kernel_name = 'gated_mix__ssm_conv_s4d__swiglu_ffn__prompt'

def setup_inputs():

    _w = (lambda a: (lambda t: t.to(torch.bfloat16) if t.is_floating_point() else t)(torch.as_tensor(a)))
    def _A_setup():
        Bsz, L, D, N = 1, 2048, 640, 192
        return {
            "u": _w((lambda *s: torch.randn(*s, dtype=torch.bfloat16) * 0.05)(Bsz, L, D)),
            "log_A_real": _w((lambda *s: torch.randn(*s, dtype=torch.bfloat16) * 6.4)(D, N) * 0.5),
            "A_imag": _w((lambda *s: torch.randn(*s, dtype=torch.bfloat16) * 0.05)(D, N) * 3.14),
            "C_real": _w((lambda *s: torch.randn(*s, dtype=torch.bfloat16) * 0.05)(D, N) / N ** 0.5),
            "C_imag": _w((lambda *s: torch.randn(*s, dtype=torch.bfloat16) * 0.05)(D, N) / N ** 0.5),
            "log_dt": _w((lambda *s: torch.randn(*s, dtype=torch.bfloat16) * 0.05)(D) * 0.5 - 4.0),
            "D_skip": _w((lambda *s: torch.randn(*s, dtype=torch.bfloat16) * 0.05)(D)),
        }
    _A_in = _A_setup()

    def _B_setup():
        B, S, D, F = 1, 2048, 640, 1536
        return {
            "x": _w((lambda *s: torch.randn(*s, dtype=torch.bfloat16) * 0.05)(B, S, D)),
            "w_gate": _w((lambda *s: torch.randn(*s, dtype=torch.bfloat16) * 0.05)(D, F)),
            "w_up": _w((lambda *s: torch.randn(*s, dtype=torch.bfloat16) * 0.05)(D, F)),
            "w_down": _w((lambda *s: torch.randn(*s, dtype=torch.bfloat16) * 0.05)(F, D)),
        }
    _B_in = _B_setup()

    return {
        "A_u": _A_in["u"],
        "A_log_A_real": _A_in["log_A_real"],
        "A_A_imag": _A_in["A_imag"],
        "A_C_real": _A_in["C_real"],
        "A_C_imag": _A_in["C_imag"],
        "A_log_dt": _A_in["log_dt"],
        "A_D_skip": _A_in["D_skip"],
        "B_x": _B_in["x"],
        "B_w_gate": _B_in["w_gate"],
        "B_w_up": _B_in["w_up"],
        "B_w_down": _B_in["w_down"],
        "gate_w": _w((lambda *s: torch.randn(*s, dtype=torch.bfloat16) * 0.05)(640) * 16.0),
    }

def reference(A_u, A_log_A_real, A_A_imag, A_C_real, A_C_imag, A_log_dt, A_D_skip, B_x, B_w_gate, B_w_up, B_w_down, gate_w):
    def _A_ref(u, log_A_real, A_imag, C_real, C_imag, log_dt, D_skip):
        L = u.shape[1]
        dt = torch.exp(log_dt)
        A = -torch.exp(log_A_real) + 1j * A_imag
        C = (C_real + 1j * C_imag) * dt[:, None]
        pos = (lambda x, dt: x.to(dt))(torch.arange(L), log_dt.dtype)
        P = torch.exp((A * dt[:, None])[:, :, None] * pos[None, None, :])
        K = 2.0 * torch.einsum("dn,dnl->dl", C, P).real
        L2 = 2 * L
        u_t = (lambda x, *d: x.permute(*d))(u, 0, 2, 1)
        Kf = (lambda x, *a, **k: torch.fft.rfft(x.float(), *a, **k))(K, L2)
        Uf = (lambda x, *a, **k: torch.fft.rfft(x.float(), *a, **k))(u_t, L2)
        y = (lambda x, *a, **k: torch.fft.irfft(x, *a, **k).to(torch.bfloat16))(Uf * Kf[None, :, :], L2)[:, :, :L]
        y = (lambda x, *d: x.permute(*d))(y, 0, 2, 1)
        return y + u * D_skip[None, None, :]

    def _B_ref(x, w_gate, w_up, w_down):
        g = _silu(x @ w_gate)
        u = x @ w_up
        return (g * u) @ w_down

    x = A_u
    g = _sigmoid((x * gate_w).sum(-1, keepdims=True))
    a = _A_ref(x, A_log_A_real, A_A_imag, A_C_real, A_C_imag, A_log_dt, A_D_skip)
    b = _B_ref(x, B_w_gate, B_w_up, B_w_down)
    return g * a + (1 - g) * b
```

```asm
; @launch grid=(256,1,1) block=(512,1,1) lds=163840
.amdgcn_target "amdgcn-amd-amdhsa--gfx950"
.text
.globl gated_mix__ssm_conv_s4d__swiglu_ffn__prompt_kernel
.p2align 8
.type gated_mix__ssm_conv_s4d__swiglu_ffn__prompt_kernel,@function
gated_mix__ssm_conv_s4d__swiglu_ffn__prompt_kernel:
    s_cmp_ge_u32 s2, 256
    s_cbranch_scc1 Lend
    v_lshrrev_b32 v1, 6, v0
    v_and_b32 v0, 63, v0
    v_readfirstlane_b32 s3, v1
    s_cmp_lg_u32 s3, 0
    s_cbranch_scc1 Lnoinit
    v_lshlrev_b32 v1, 3, v0
    v_cmp_gt_u32 vcc, 48, v0
    v_add_u32 v1, 163200, v1
    s_nop 0
    v_cndmask_b32 v2, 0, 1, vcc
    v_mov_b32 v3, v2
    ds_write_b64 v1, v[2:3]
    s_getpc_b64 s[4:5]
Lpc:
    s_lshr_b32 s6, s2, 3
    s_mul_i32 s6, s6, 1280
    v_lshl_add_u32 v12, v0, 7, s6
    v_min_u32 v12, Lend-Lpc, v12
    v_mov_b32 v13, s5
    v_add_co_u32 v12, vcc, s4, v12
    s_nop 1
    v_addc_co_u32 v13, vcc, 0, v13, vcc
    s_mov_b64 exec, 0x3ff
    global_load_dword v1, v[12:13], off
    s_mov_b64 exec, -1
    s_waitcnt lgkmcnt(0)
Lnoinit:
    s_load_dwordx16 s[36:51], s[0:1], 0
    s_load_dwordx8 s[52:59], s[0:1], 64
    s_load_dwordx4 s[60:63], s[0:1], 96
    s_load_dwordx2 s[64:65], s[0:1], 112
    s_barrier
    s_and_b32 s66, s2, 7
    s_lshr_b32 s67, s2, 3
    s_lshr_b32 s6, s66, 2
    s_lshl_b32 s6, s6, 3
    s_and_b32 s7, s67, 7
    s_add_u32 s28, s6, s7
    s_cmp_ge_u32 s67, 24
    s_cbranch_scc1 LSC
    s_cmp_lt_u32 s3, 4
    s_cbranch_scc1 LG
    s_cmp_eq_u32 s3, 6
    s_cbranch_scc1 LS6
    s_cmp_eq_u32 s3, 7
    s_cbranch_scc1 LJ
LL:
    s_and_b32 s6, s66, 3
    s_mul_i32 s6, s6, 3
    s_lshr_b32 s7, s67, 3
    s_add_u32 s29, s6, s7
    s_setprio 0
    s_sub_u32 s35, s3, 4
    v_lshrrev_b32 v12, 3, v0
    s_lshl_b32 s4, s28, 7
    s_lshl_b32 s5, s35, 6
    s_add_u32 s4, s4, s5
    v_add_u32 v12, s4, v12
    v_mul_u32_u24 v12, 1280, v12
    v_and_b32 v13, 7, v0
    v_lshrrev_b32 v14, 4, v0
    v_xor_b32 v13, v13, v14
    v_lshl_add_u32 v2, v13, 4, v12
    v_xor_b32 v3, 64, v2
    v_mul_u32_u24 v12, 3072, v14
    v_and_b32 v13, 15, v0
    v_lshlrev_b32 v14, 1, v14
    v_xor_b32 v13, v13, v14
    v_lshl_add_u32 v12, v13, 4, v12
    s_lshl_b32 s4, s29, 8
    v_add_u32_e64 v4, s4, v12
    v_xor_b32 v5, 0x80, v4
    v_add_u32 v24, 9216, v3
    v_add_u32 v28, 11264, v4
    v_add_u32 v25, 18432, v2
    v_add_u32 v29, 22528, v5
    v_add_u32 v26, 27648, v3
    v_add_u32 v30, 33792, v5
    v_mov_b32 v10, 163200
    v_mov_b32 v9, 163200
    s_lshl_b32 s18, s35, 2
    s_add_u32 s18, s18, 163200
    s_mov_b32 s33, 0
    s_lshl_b32 s34, s35, 13
    s_lshl_b32 s30, s35, 13
    s_add_u32 s30, s30, 16384
    s_mov_b32 s16, 0
    s_mov_b32 s17, 0
    s_mov_b32 s10, 2621440
    s_mov_b32 s11, 0x20000
    s_mov_b32 s14, 1966080
    s_mov_b32 s15, 0x20000
    s_cmp_eq_u32 s35, 0
    s_waitcnt lgkmcnt(0)
    s_mov_b64 s[8:9], s[36:37]
    s_cselect_b32 s12, s52, s54
    s_cselect_b32 s13, s53, s55
LLDloop:
    s_mov_b32 m0, s34
    s_nop 0
    buffer_load_dwordx4 v2, s[8:11], s16 offen offset:0  lds
    buffer_load_dwordx4 v24, s[8:11], s16 offen offset:1024  lds
    buffer_load_dwordx4 v25, s[8:11], s16 offen offset:2048  lds
    buffer_load_dwordx4 v26, s[8:11], s16 offen offset:3072  lds
    s_add_u32 m0, m0, 4096
    s_add_u32 s19, s16, 40960
    buffer_load_dwordx4 v2, s[8:11], s19 offen offset:0  lds
    buffer_load_dwordx4 v24, s[8:11], s19 offen offset:1024  lds
    buffer_load_dwordx4 v25, s[8:11], s19 offen offset:2048  lds
    buffer_load_dwordx4 v26, s[8:11], s19 offen offset:3072  lds
    s_add_u32 m0, s34, s30
    s_add_u32 s16, s16, 128
    buffer_load_dwordx4 v4, s[12:15], s17 offen offset:0  lds
    buffer_load_dwordx4 v28, s[12:15], s17 offen offset:1024  lds
    buffer_load_dwordx4 v29, s[12:15], s17 offen offset:2048  lds
    buffer_load_dwordx4 v30, s[12:15], s17 offen offset:3072  lds
    s_add_u32 m0, m0, 4096
    s_add_u32 s17, s17, 49152
    buffer_load_dwordx4 v4, s[12:15], s17 offen offset:0  lds
    buffer_load_dwordx4 v28, s[12:15], s17 offen offset:1024  lds
    buffer_load_dwordx4 v29, s[12:15], s17 offen offset:2048  lds
    buffer_load_dwordx4 v30, s[12:15], s17 offen offset:3072  lds
    s_mov_b32 s6, m0
    s_mov_b32 m0, s18
    s_mov_b64 exec, 1
    buffer_load_dword off, s[8:11], s10 lds
    s_mov_b64 exec, -1
    s_mov_b32 m0, s6
    s_nop 0
    s_add_u32 m0, m0, 4096
    s_add_u32 s17, s17, 49152
    buffer_load_dwordx4 v4, s[12:15], s17 offen offset:0  lds
    buffer_load_dwordx4 v28, s[12:15], s17 offen offset:1024  lds
    buffer_load_dwordx4 v29, s[12:15], s17 offen offset:2048  lds
    buffer_load_dwordx4 v30, s[12:15], s17 offen offset:3072  lds
    s_add_u32 m0, m0, 4096
    s_add_u32 s17, s17, 49152
    buffer_load_dwordx4 v4, s[12:15], s17 offen offset:0  lds
    buffer_load_dwordx4 v28, s[12:15], s17 offen offset:1024  lds
    buffer_load_dwordx4 v29, s[12:15], s17 offen offset:2048  lds
    buffer_load_dwordx4 v30, s[12:15], s17 offen offset:3072  lds
    s_add_u32 m0, s18, 8
    s_mov_b64 exec, 1
    buffer_load_dword off, s[8:11], s10 lds
    s_mov_b64 exec, -1
    s_add_u32 s17, s17, 49152
    s_add_u32 s34, s34, 49152
    s_sub_u32 s4, s34, 147456
    s_cmp_ge_u32 s34, 147456
    s_cselect_b32 s34, s4, s34
    s_add_u32 s18, s18, 16
    s_add_u32 s33, s33, 2
    s_waitcnt vmcnt(36)
    s_cmp_lt_u32 s33, 6
    s_cbranch_scc1 LLDloop
    s_cmp_eq_u32 s33, 20
    s_cbranch_scc1 LLDfin
    s_mov_b32 s5, 0
Lzs1:
    ds_read_b128 v[12:15], v9 offset:160
    s_add_u32 s5, s5, 1
    s_waitcnt lgkmcnt(0)
    v_or3_b32 v12, v12, v13, v14
    v_or_b32 v12, v12, v15
    v_cmp_eq_u32 vcc, 0, v12
    s_cbranch_vccnz Lzse2
    s_sleep 1
    s_cmp_lt_u32 s5, 1048576
    s_cbranch_scc1 Lzs1
Lzse2:
    v_add_u32 v9, 16, v9
    s_branch LLDloop
LLDfin:
    s_mov_b64 s[20:21], s[64:65]
    s_mov_b32 s22, 0x1080000
    s_mov_b32 s23, 0x20000
    s_lshr_b32 s6, s66, 1
    s_lshl_b32 s6, s6, 3
    s_and_b32 s7, s67, 7
    s_add_u32 s31, s6, s7
    s_and_b32 s6, s66, 1
    s_lshl_b32 s6, s6, 2
    s_lshr_b32 s7, s67, 3
    s_add_u32 s32, s6, s7
    v_lshlrev_b32_e64 v2, 4, v0
    s_mul_i32 s7, s32, 245760
    s_add_u32 s7, s7, 5373952
    v_lshl_add_u32 v9, s35, 2, v10
    s_mov_b32 s5, 0
Lls3:
    ds_read_b32 v12, v10 offset:404
    s_add_u32 s5, s5, 1
    s_waitcnt lgkmcnt(0)
    v_readfirstlane_b32 s4, v12
    s_cmp_ge_u32 s4, 1
    s_cbranch_scc1 Llse4
    s_sleep 2
    s_cmp_lt_u32 s5, 1048576
    s_cbranch_scc1 Lls3
Llse4:
    s_add_u32 s7, s7, 30720
    s_cmp_lg_u32 s35, 0
    s_cbranch_scc1 LWD1
    s_mov_b32 s5, 0
Lzs5:
    ds_read_b128 v[12:15], v10 offset:272
    s_add_u32 s5, s5, 1
    s_waitcnt lgkmcnt(0)
    v_or3_b32 v12, v12, v13, v14
    v_or_b32 v12, v12, v15
    v_cmp_eq_u32 vcc, 0, v12
    s_cbranch_vccnz Lzse6
    s_sleep 1
    s_cmp_lt_u32 s5, 1048576
    s_cbranch_scc1 Lzs5
Lzse6:
    s_mov_b32 m0, 49152
    s_add_u32 s6, s7, 79872
    buffer_load_dwordx4 v2, s[20:23], s6 offen offset:0 sc1 lds
    buffer_load_dwordx4 v2, s[20:23], s6 offen offset:1024 sc1 lds
    buffer_load_dwordx4 v2, s[20:23], s6 offen offset:2048 sc1 lds
    buffer_load_dwordx4 v2, s[20:23], s6 offen offset:3072 sc1 lds
    s_mov_b32 m0, 53248
    s_add_u32 s6, s7, 83968
    buffer_load_dwordx4 v2, s[20:23], s6 offen offset:0 sc1 lds
    buffer_load_dwordx4 v2, s[20:23], s6 offen offset:1024 sc1 lds
    buffer_load_dwordx4 v2, s[20:23], s6 offen offset:2048 sc1 lds
    buffer_load_dwordx4 v2, s[20:23], s6 offen offset:3072 sc1 lds
    s_mov_b32 m0, 57344
    s_add_u32 s6, s7, 88064
    buffer_load_dwordx4 v2, s[20:23], s6 offen offset:0 sc1 lds
    buffer_load_dwordx4 v2, s[20:23], s6 offen offset:1024 sc1 lds
    buffer_load_dwordx4 v2, s[20:23], s6 offen offset:2048 sc1 lds
    buffer_load_dwordx4 v2, s[20:23], s6 offen offset:3072 sc1 lds
    s_mov_b32 m0, 61440
    s_add_u32 s6, s7, 122880
    buffer_load_dwordx4 v2, s[20:23], s6 offen offset:0 sc1 lds
    buffer_load_dwordx4 v2, s[20:23], s6 offen offset:1024 sc1 lds
    buffer_load_dwordx4 v2, s[20:23], s6 offen offset:2048 sc1 lds
    buffer_load_dwordx4 v2, s[20:23], s6 offen offset:3072 sc1 lds
    s_mov_b32 m0, 65536
    s_add_u32 s6, s7, 126976
    buffer_load_dwordx4 v2, s[20:23], s6 offen offset:0 sc1 lds
    buffer_load_dwordx4 v2, s[20:23], s6 offen offset:1024 sc1 lds
    buffer_load_dwordx4 v2, s[20:23], s6 offen offset:2048 sc1 lds
    buffer_load_dwordx4 v2, s[20:23], s6 offen offset:3072 sc1 lds
    s_mov_b32 m0, 69632
    s_add_u32 s6, s7, 131072
    buffer_load_dwordx4 v2, s[20:23], s6 offen offset:0 sc1 lds
    buffer_load_dwordx4 v2, s[20:23], s6 offen offset:1024 sc1 lds
    buffer_load_dwordx4 v2, s[20:23], s6 offen offset:2048 sc1 lds
    buffer_load_dwordx4 v2, s[20:23], s6 offen offset:3072 sc1 lds
    s_mov_b32 s5, 0
Lzs7:
    ds_read_b128 v[12:15], v10 offset:288
    s_add_u32 s5, s5, 1
    s_waitcnt lgkmcnt(0)
    v_or3_b32 v12, v12, v13, v14
    v_or_b32 v12, v12, v15
    v_cmp_eq_u32 vcc, 0, v12
    s_cbranch_vccnz Lzse8
    s_sleep 1
    s_cmp_lt_u32 s5, 1048576
    s_cbranch_scc1 Lzs7
Lzse8:
    s_mov_b32 m0, 98304
    s_add_u32 s6, s7, 190464
    buffer_load_dwordx4 v2, s[20:23], s6 offen offset:0 sc1 lds
    buffer_load_dwordx4 v2, s[20:23], s6 offen offset:1024 sc1 lds
    buffer_load_dwordx4 v2, s[20:23], s6 offen offset:2048 sc1 lds
    buffer_load_dwordx4 v2, s[20:23], s6 offen offset:3072 sc1 lds
    s_mov_b32 m0, 102400
    s_add_u32 s6, s7, 194560
    buffer_load_dwordx4 v2, s[20:23], s6 offen offset:0 sc1 lds
    buffer_load_dwordx4 v2, s[20:23], s6 offen offset:1024 sc1 lds
    buffer_load_dwordx4 v2, s[20:23], s6 offen offset:2048 sc1 lds
    buffer_load_dwordx4 v2, s[20:23], s6 offen offset:3072 sc1 lds
    s_mov_b32 m0, 106496
    s_add_u32 s6, s7, 198656
    buffer_load_dwordx4 v2, s[20:23], s6 offen offset:0 sc1 lds
    buffer_load_dwordx4 v2, s[20:23], s6 offen offset:1024 sc1 lds
    buffer_load_dwordx4 v2, s[20:23], s6 offen offset:2048 sc1 lds
    buffer_load_dwordx4 v2, s[20:23], s6 offen offset:3072 sc1 lds
    s_mov_b32 s5, 0
Lzs9:
    ds_read_b128 v[12:15], v10 offset:304
    s_add_u32 s5, s5, 1
    s_waitcnt lgkmcnt(0)
    v_or3_b32 v12, v12, v13, v14
    v_or_b32 v12, v12, v15
    v_cmp_eq_u32 vcc, 0, v12
    s_cbranch_vccnz Lzse10
    s_sleep 1
    s_cmp_lt_u32 s5, 1048576
    s_cbranch_scc1 Lzs9
Lzse10:
    s_mov_b32 m0, 0
    s_add_u32 s6, s7, 0
    buffer_load_dwordx4 v2, s[20:23], s6 offen offset:0 sc1 lds
    buffer_load_dwordx4 v2, s[20:23], s6 offen offset:1024 sc1 lds
    buffer_load_dwordx4 v2, s[20:23], s6 offen offset:2048 sc1 lds
    buffer_load_dwordx4 v2, s[20:23], s6 offen offset:3072 sc1 lds
    s_mov_b32 m0, 4096
    s_add_u32 s6, s7, 4096
    buffer_load_dwordx4 v2, s[20:23], s6 offen offset:0 sc1 lds
    buffer_load_dwordx4 v2, s[20:23], s6 offen offset:1024 sc1 lds
    buffer_load_dwordx4 v2, s[20:23], s6 offen offset:2048 sc1 lds
    buffer_load_dwordx4 v2, s[20:23], s6 offen offset:3072 sc1 lds
    s_mov_b32 m0, 8192
    s_add_u32 s6, s7, 8192
    buffer_load_dwordx4 v2, s[20:23], s6 offen offset:0 sc1 lds
    buffer_load_dwordx4 v2, s[20:23], s6 offen offset:1024 sc1 lds
    buffer_load_dwordx4 v2, s[20:23], s6 offen offset:2048 sc1 lds
    buffer_load_dwordx4 v2, s[20:23], s6 offen offset:3072 sc1 lds
    s_mov_b32 m0, 12288
    s_add_u32 s6, s7, 12288
    buffer_load_dwordx4 v2, s[20:23], s6 offen offset:0 sc1 lds
    buffer_load_dwordx4 v2, s[20:23], s6 offen offset:1024 sc1 lds
    buffer_load_dwordx4 v2, s[20:23], s6 offen offset:2048 sc1 lds
    buffer_load_dwordx4 v2, s[20:23], s6 offen offset:3072 sc1 lds
    s_mov_b32 m0, 16384
    s_add_u32 s6, s7, 16384
    buffer_load_dwordx4 v2, s[20:23], s6 offen offset:0 sc1 lds
    buffer_load_dwordx4 v2, s[20:23], s6 offen offset:1024 sc1 lds
    buffer_load_dwordx4 v2, s[20:23], s6 offen offset:2048 sc1 lds
    buffer_load_dwordx4 v2, s[20:23], s6 offen offset:3072 sc1 lds
    s_mov_b32 m0, 20480
    s_add_u32 s6, s7, 20480
    buffer_load_dwordx4 v2, s[20:23], s6 offen offset:0 sc1 lds
    buffer_load_dwordx4 v2, s[20:23], s6 offen offset:1024 sc1 lds
    buffer_load_dwordx4 v2, s[20:23], s6 offen offset:2048 sc1 lds
    buffer_load_dwordx4 v2, s[20:23], s6 offen offset:3072 sc1 lds
    s_branch LWDe
LWD1:
    s_mov_b32 s5, 0
Lzs11:
    ds_read_b128 v[12:15], v10 offset:272
    s_add_u32 s5, s5, 1
    s_waitcnt lgkmcnt(0)
    v_or3_b32 v12, v12, v13, v14
    v_or_b32 v12, v12, v15
    v_cmp_eq_u32 vcc, 0, v12
    s_cbranch_vccnz Lzse12
    s_sleep 1
    s_cmp_lt_u32 s5, 1048576
    s_cbranch_scc1 Lzs11
Lzse12:
    s_nop 0
    s_mov_b32 m0, 73728
    s_add_u32 s6, s7, 135168
    buffer_load_dwordx4 v2, s[20:23], s6 offen offset:0 sc1 lds
    buffer_load_dwordx4 v2, s[20:23], s6 offen offset:1024 sc1 lds
    buffer_load_dwordx4 v2, s[20:23], s6 offen offset:2048 sc1 lds
    buffer_load_dwordx4 v2, s[20:23], s6 offen offset:3072 sc1 lds
    s_mov_b32 m0, 77824
    s_add_u32 s6, s7, 139264
    buffer_load_dwordx4 v2, s[20:23], s6 offen offset:0 sc1 lds
    buffer_load_dwordx4 v2, s[20:23], s6 offen offset:1024 sc1 lds
    buffer_load_dwordx4 v2, s[20:23], s6 offen offset:2048 sc1 lds
    buffer_load_dwordx4 v2, s[20:23], s6 offen offset:3072 sc1 lds
    s_mov_b32 m0, 81920
    s_add_u32 s6, s7, 143360
    buffer_load_dwordx4 v2, s[20:23], s6 offen offset:0 sc1 lds
    buffer_load_dwordx4 v2, s[20:23], s6 offen offset:1024 sc1 lds
    buffer_load_dwordx4 v2, s[20:23], s6 offen offset:2048 sc1 lds
    buffer_load_dwordx4 v2, s[20:23], s6 offen offset:3072 sc1 lds
    s_mov_b32 m0, 86016
    s_add_u32 s6, s7, 147456
    buffer_load_dwordx4 v2, s[20:23], s6 offen offset:0 sc1 lds
    buffer_load_dwordx4 v2, s[20:23], s6 offen offset:1024 sc1 lds
    buffer_load_dwordx4 v2, s[20:23], s6 offen offset:2048 sc1 lds
    buffer_load_dwordx4 v2, s[20:23], s6 offen offset:3072 sc1 lds
    s_mov_b32 m0, 90112
    s_add_u32 s6, s7, 151552
    buffer_load_dwordx4 v2, s[20:23], s6 offen offset:0 sc1 lds
    buffer_load_dwordx4 v2, s[20:23], s6 offen offset:1024 sc1 lds
    s_mov_b32 m0, 92160
    s_add_u32 s6, s7, 184320
    buffer_load_dwordx4 v2, s[20:23], s6 offen offset:0 sc1 lds
    buffer_load_dwordx4 v2, s[20:23], s6 offen offset:1024 sc1 lds
    buffer_load_dwordx4 v2, s[20:23], s6 offen offset:2048 sc1 lds
    buffer_load_dwordx4 v2, s[20:23], s6 offen offset:3072 sc1 lds
    s_mov_b32 m0, 96256
    s_add_u32 s6, s7, 188416
    buffer_load_dwordx4 v2, s[20:23], s6 offen offset:0 sc1 lds
    buffer_load_dwordx4 v2, s[20:23], s6 offen offset:1024 sc1 lds
    s_mov_b32 s5, 0
Lzs13:
    ds_read_b128 v[12:15], v10 offset:288
    s_add_u32 s5, s5, 1
    s_waitcnt lgkmcnt(0)
    v_or3_b32 v12, v12, v13, v14
    v_or_b32 v12, v12, v15
    v_cmp_eq_u32 vcc, 0, v12
    s_cbranch_vccnz Lzse14
    s_sleep 1
    s_cmp_lt_u32 s5, 1048576
    s_cbranch_scc1 Lzs13
Lzse14:
    s_mov_b32 m0, 110592
    s_add_u32 s6, s7, 202752
    buffer_load_dwordx4 v2, s[20:23], s6 offen offset:0 sc1 lds
    buffer_load_dwordx4 v2, s[20:23], s6 offen offset:1024 sc1 lds
    buffer_load_dwordx4 v2, s[20:23], s6 offen offset:2048 sc1 lds
    buffer_load_dwordx4 v2, s[20:23], s6 offen offset:3072 sc1 lds
    s_mov_b32 m0, 114688
    s_add_u32 s6, s7, 206848
    buffer_load_dwordx4 v2, s[20:23], s6 offen offset:0 sc1 lds
    buffer_load_dwordx4 v2, s[20:23], s6 offen offset:1024 sc1 lds
    buffer_load_dwordx4 v2, s[20:23], s6 offen offset:2048 sc1 lds
    buffer_load_dwordx4 v2, s[20:23], s6 offen offset:3072 sc1 lds
    s_mov_b32 m0, 118784
    s_add_u32 s6, s7, 210944
    buffer_load_dwordx4 v2, s[20:23], s6 offen offset:0 sc1 lds
    buffer_load_dwordx4 v2, s[20:23], s6 offen offset:1024 sc1 lds
    buffer_load_dwordx4 v2, s[20:23], s6 offen offset:2048 sc1 lds
    buffer_load_dwordx4 v2, s[20:23], s6 offen offset:3072 sc1 lds
    s_mov_b32 s5, 0
Lzs15:
    ds_read_b128 v[12:15], v10 offset:304
    s_add_u32 s5, s5, 1
    s_waitcnt lgkmcnt(0)
    v_or3_b32 v12, v12, v13, v14
    v_or_b32 v12, v12, v15
    v_cmp_eq_u32 vcc, 0, v12
    s_cbranch_vccnz Lzse16
    s_sleep 1
    s_cmp_lt_u32 s5, 1048576
    s_cbranch_scc1 Lzs15
Lzse16:
    s_mov_b32 m0, 24576
    s_add_u32 s6, s7, 24576
    buffer_load_dwordx4 v2, s[20:23], s6 offen offset:0 sc1 lds
    buffer_load_dwordx4 v2, s[20:23], s6 offen offset:1024 sc1 lds
    buffer_load_dwordx4 v2, s[20:23], s6 offen offset:2048 sc1 lds
    buffer_load_dwordx4 v2, s[20:23], s6 offen offset:3072 sc1 lds
    s_mov_b32 m0, 28672
    s_add_u32 s6, s7, 28672
    buffer_load_dwordx4 v2, s[20:23], s6 offen offset:0 sc1 lds
    buffer_load_dwordx4 v2, s[20:23], s6 offen offset:1024 sc1 lds
    s_mov_b32 m0, 30720
    s_add_u32 s6, s7, 61440
    buffer_load_dwordx4 v2, s[20:23], s6 offen offset:0 sc1 lds
    buffer_load_dwordx4 v2, s[20:23], s6 offen offset:1024 sc1 lds
    buffer_load_dwordx4 v2, s[20:23], s6 offen offset:2048 sc1 lds
    buffer_load_dwordx4 v2, s[20:23], s6 offen offset:3072 sc1 lds
    s_mov_b32 m0, 34816
    s_add_u32 s6, s7, 65536
    buffer_load_dwordx4 v2, s[20:23], s6 offen offset:0 sc1 lds
    buffer_load_dwordx4 v2, s[20:23], s6 offen offset:1024 sc1 lds
    buffer_load_dwordx4 v2, s[20:23], s6 offen offset:2048 sc1 lds
    buffer_load_dwordx4 v2, s[20:23], s6 offen offset:3072 sc1 lds
    s_mov_b32 m0, 38912
    s_add_u32 s6, s7, 69632
    buffer_load_dwordx4 v2, s[20:23], s6 offen offset:0 sc1 lds
    buffer_load_dwordx4 v2, s[20:23], s6 offen offset:1024 sc1 lds
    buffer_load_dwordx4 v2, s[20:23], s6 offen offset:2048 sc1 lds
    buffer_load_dwordx4 v2, s[20:23], s6 offen offset:3072 sc1 lds
    s_mov_b32 m0, 43008
    s_add_u32 s6, s7, 73728
    buffer_load_dwordx4 v2, s[20:23], s6 offen offset:0 sc1 lds
    buffer_load_dwordx4 v2, s[20:23], s6 offen offset:1024 sc1 lds
    buffer_load_dwordx4 v2, s[20:23], s6 offen offset:2048 sc1 lds
    buffer_load_dwordx4 v2, s[20:23], s6 offen offset:3072 sc1 lds
    s_mov_b32 m0, 47104
    s_add_u32 s6, s7, 77824
    buffer_load_dwordx4 v2, s[20:23], s6 offen offset:0 sc1 lds
    buffer_load_dwordx4 v2, s[20:23], s6 offen offset:1024 sc1 lds
LWDe:
    s_lshl_b32 s4, s35, 2
    s_add_u32 m0, s4, 163560
    s_mov_b64 exec, 1
    buffer_load_dword off, s[20:23], s22 lds
    s_mov_b64 exec, -1
    s_mov_b64 s[24:25], s[62:63]
    s_mov_b32 s26, 0x100
    s_mov_b32 s27, 0x20000
    s_branch Lcoop
LG:
    s_waitcnt lgkmcnt(0)
    s_mov_b64 s[20:21], s[64:65]
    s_mov_b32 s22, 0x1080000
    s_mov_b32 s23, 0x20000
    s_mov_b64 s[24:25], s[62:63]
    s_mov_b32 s26, 0x100
    s_mov_b32 s27, 0x20000
LGgo:
    s_setprio 2
    s_and_b32 s6, s66, 3
    s_mul_i32 s6, s6, 3
    s_lshr_b32 s7, s67, 3
    s_add_u32 s29, s6, s7
    s_lshr_b32 s6, s66, 1
    s_lshl_b32 s6, s6, 3
    s_and_b32 s7, s67, 7
    s_add_u32 s31, s6, s7
    s_and_b32 s6, s66, 1
    s_lshl_b32 s6, s6, 2
    s_lshr_b32 s7, s67, 3
    s_add_u32 s32, s6, s7
    s_and_b32 s8, s3, 1
    s_lshr_b32 s9, s3, 1
    v_and_b32 v16, 15, v0
    v_lshrrev_b32 v17, 4, v0
    v_bfe_u32 v18, v0, 1, 3
    v_xor_b32 v18, v18, v17
    s_lshl_b32 s4, s8, 13
    v_lshlrev_b32 v16, 7, v16
    v_lshl_add_u32 v16, v18, 4, v16
    v_add_u32_e64 v2, s4, v16
    v_bfe_u32 v18, v0, 2, 2
    v_lshl_add_u32 v19, v17, 3, v18
    v_lshlrev_b32 v19, 8, v19
    v_and_b32 v16, 3, v0
    v_lshl_add_u32 v19, v16, 3, v19
    v_and_b32 v16, 1, v17
    v_xor_b32 v16, s9, v16
    v_lshl_add_u32 v18, v16, 2, v18
    v_lshl_add_u32 v19, v18, 5, v19
    v_add_u32 v6, 16384, v19
    v_mov_b32 v13, 163200
    v_mov_b32 v11, 163200
    s_lshl_b32 s4, s3, 2
    s_add_u32 s4, s4, 163344
    s_mov_b32 m0, s4
    s_mov_b32 s33, 0
    s_mov_b32 s34, 0
    v_lshlrev_b32_e64 v5, 4, v0
    s_mul_i32 s18, s32, 245760
    s_mul_i32 s7, s3, 61440
    s_add_u32 s18, s18, s7
    s_add_u32 s18, s18, 5373952
    v_add_u32 v3, s34, v2
    v_add_u32 v7, s34, v6
    v_xor_b32 v4, 64, v3
    v_xor_b32 v8, 32, v7
    v_xor_b32 v9, 64, v7
    v_xor_b32 v10, 96, v7
    v_mov_b64 v[128:129], 0
    v_mov_b64 v[130:131], 0
    v_mov_b64 v[132:133], 0
    v_mov_b64 v[134:135], 0
    v_mov_b64 v[136:137], 0
    v_mov_b64 v[138:139], 0
    v_mov_b64 v[140:141], 0
    v_mov_b64 v[142:143], 0
    v_mov_b64 v[144:145], 0
    v_mov_b64 v[146:147], 0
    v_mov_b64 v[148:149], 0
    v_mov_b64 v[150:151], 0
    v_mov_b64 v[152:153], 0
    v_mov_b64 v[154:155], 0
    v_mov_b64 v[156:157], 0
    v_mov_b64 v[158:159], 0
    v_mov_b64 v[160:161], 0
    v_mov_b64 v[162:163], 0
    v_mov_b64 v[164:165], 0
    v_mov_b64 v[166:167], 0
    v_mov_b64 v[168:169], 0
    v_mov_b64 v[170:171], 0
    v_mov_b64 v[172:173], 0
    v_mov_b64 v[174:175], 0
    v_mov_b64 v[176:177], 0
    v_mov_b64 v[178:179], 0
    v_mov_b64 v[180:181], 0
    v_mov_b64 v[182:183], 0
    v_mov_b64 v[184:185], 0
    v_mov_b64 v[186:187], 0
    v_mov_b64 v[188:189], 0
    v_mov_b64 v[190:191], 0
    v_mov_b64 v[192:193], 0
    v_mov_b64 v[194:195], 0
    v_mov_b64 v[196:197], 0
    v_mov_b64 v[198:199], 0
    v_mov_b64 v[200:201], 0
    v_mov_b64 v[202:203], 0
    v_mov_b64 v[204:205], 0
    v_mov_b64 v[206:207], 0
    v_mov_b64 v[208:209], 0
    v_mov_b64 v[210:211], 0
    v_mov_b64 v[212:213], 0
    v_mov_b64 v[214:215], 0
    v_mov_b64 v[216:217], 0
    v_mov_b64 v[218:219], 0
    v_mov_b64 v[220:221], 0
    v_mov_b64 v[222:223], 0
    v_mov_b64 v[224:225], 0
    v_mov_b64 v[226:227], 0
    v_mov_b64 v[228:229], 0
    v_mov_b64 v[230:231], 0
    v_mov_b64 v[232:233], 0
    v_mov_b64 v[234:235], 0
    v_mov_b64 v[236:237], 0
    v_mov_b64 v[238:239], 0
    v_mov_b64 v[240:241], 0
    v_mov_b64 v[242:243], 0
    v_mov_b64 v[244:245], 0
    v_mov_b64 v[246:247], 0
    v_mov_b64 v[248:249], 0
    v_mov_b64 v[250:251], 0
    v_mov_b64 v[252:253], 0
    v_mov_b64 v[254:255], 0
    s_mov_b32 s5, 0
Lzs17:
    ds_read_b64 v[14:15], v13 offset:0
    s_add_u32 s5, s5, 1
    s_waitcnt lgkmcnt(0)
    v_or_b32 v14, v14, v15
    v_cmp_eq_u32 vcc, 0, v14
    s_cbranch_vccnz Lzse18
    s_sleep 1
    s_cmp_lt_u32 s5, 1048576
    s_cbranch_scc1 Lzs17
Lzse18:
    ds_read_b64_tr_b16 v[32:33], v7 offset:0
    ds_read_b64_tr_b16 v[34:35], v7 offset:1024
    ds_read_b128 v[64:67], v3 offset:0
    ds_read_b128 v[68:71], v3 offset:2048
    ds_read_b128 v[72:75], v3 offset:4096
    ds_read_b128 v[76:79], v3 offset:6144
    ds_read_b64_tr_b16 v[48:49], v7 offset:16384
    ds_read_b64_tr_b16 v[50:51], v7 offset:17408
    ds_read_b64_tr_b16 v[36:37], v8 offset:0
    ds_read_b64_tr_b16 v[38:39], v8 offset:1024
    ds_read_b64_tr_b16 v[52:53], v8 offset:16384
    ds_read_b64_tr_b16 v[54:55], v8 offset:17408
    ds_read_b64_tr_b16 v[40:41], v9 offset:0
    ds_read_b64_tr_b16 v[42:43], v9 offset:1024
    ds_read_b64_tr_b16 v[56:57], v9 offset:16384
    ds_read_b64_tr_b16 v[58:59], v9 offset:17408
    ds_read_b64_tr_b16 v[44:45], v10 offset:0
    ds_read_b64_tr_b16 v[46:47], v10 offset:1024
    ds_read_b64_tr_b16 v[60:61], v10 offset:16384
    ds_read_b64_tr_b16 v[62:63], v10 offset:17408
    ds_read_b64 v[14:15], v11 offset:8
LG1loop:
    s_waitcnt lgkmcnt(0)
    v_mfma_f32_16x16x32_bf16 v[128:131], v[32:35], v[64:67], v[128:131]
    v_or_b32 v14, v14, v15
    v_mfma_f32_16x16x32_bf16 v[132:135], v[32:35], v[68:71], v[132:135]
    v_cmp_ne_u32 vcc, 0, v14
    v_mfma_f32_16x16x32_bf16 v[136:139], v[32:35], v[72:75], v[136:139]
    s_cbranch_vccnz LG1w0
LG1r0:
    v_mfma_f32_16x16x32_bf16 v[140:143], v[32:35], v[76:79], v[140:143]
    ds_read_b64_tr_b16 v[80:81], v7 offset:8192
    v_mfma_f32_16x16x32_bf16 v[204:207], v[48:51], v[76:79], v[204:207]
    ds_read_b64_tr_b16 v[82:83], v7 offset:9216
    v_mfma_f32_16x16x32_bf16 v[200:203], v[48:51], v[72:75], v[200:203]
    ds_read_b128 v[112:115], v4 offset:0
    v_mfma_f32_16x16x32_bf16 v[196:199], v[48:51], v[68:71], v[196:199]
    ds_read_b128 v[116:119], v4 offset:2048
    v_mfma_f32_16x16x32_bf16 v[192:195], v[48:51], v[64:67], v[192:195]
    ds_read_b128 v[120:123], v4 offset:4096
    v_mfma_f32_16x16x32_bf16 v[144:147], v[36:39], v[64:67], v[144:147]
    ds_read_b128 v[124:127], v4 offset:6144
    v_mfma_f32_16x16x32_bf16 v[148:151], v[36:39], v[68:71], v[148:151]
    ds_read_b64_tr_b16 v[96:97], v7 offset:24576
    v_mfma_f32_16x16x32_bf16 v[152:155], v[36:39], v[72:75], v[152:155]
    ds_read_b64_tr_b16 v[98:99], v7 offset:25600
    v_mfma_f32_16x16x32_bf16 v[156:159], v[36:39], v[76:79], v[156:159]
    ds_read_b64_tr_b16 v[84:85], v8 offset:8192
    v_mfma_f32_16x16x32_bf16 v[220:223], v[52:55], v[76:79], v[220:223]
    ds_read_b64_tr_b16 v[86:87], v8 offset:9216
    v_mfma_f32_16x16x32_bf16 v[216:219], v[52:55], v[72:75], v[216:219]
    ds_read_b64_tr_b16 v[100:101], v8 offset:24576
    v_mfma_f32_16x16x32_bf16 v[212:215], v[52:55], v[68:71], v[212:215]
    ds_read_b64_tr_b16 v[102:103], v8 offset:25600
    v_mfma_f32_16x16x32_bf16 v[208:211], v[52:55], v[64:67], v[208:211]
    ds_read_b64_tr_b16 v[88:89], v9 offset:8192
    v_mfma_f32_16x16x32_bf16 v[160:163], v[40:43], v[64:67], v[160:163]
    ds_read_b64_tr_b16 v[90:91], v9 offset:9216
    v_mfma_f32_16x16x32_bf16 v[164:167], v[40:43], v[68:71], v[164:167]
    ds_read_b64_tr_b16 v[104:105], v9 offset:24576
    v_mfma_f32_16x16x32_bf16 v[168:171], v[40:43], v[72:75], v[168:171]
    ds_read_b64_tr_b16 v[106:107], v9 offset:25600
    v_mfma_f32_16x16x32_bf16 v[172:175], v[40:43], v[76:79], v[172:175]
    ds_read_b64_tr_b16 v[92:93], v10 offset:8192
    v_mfma_f32_16x16x32_bf16 v[236:239], v[56:59], v[76:79], v[236:239]
    ds_read_b64_tr_b16 v[94:95], v10 offset:9216
    v_mfma_f32_16x16x32_bf16 v[232:235], v[56:59], v[72:75], v[232:235]
    ds_read_b64_tr_b16 v[108:109], v10 offset:24576
    v_mfma_f32_16x16x32_bf16 v[228:231], v[56:59], v[68:71], v[228:231]
    ds_read_b64_tr_b16 v[110:111], v10 offset:25600
    v_mfma_f32_16x16x32_bf16 v[224:227], v[56:59], v[64:67], v[224:227]
    ds_read_b64 v[14:15], v11 offset:16
    v_mfma_f32_16x16x32_bf16 v[176:179], v[44:47], v[64:67], v[176:179]
    s_add_u32 s33, s33, 2
    s_add_u32 s34, s34, 49152
    v_mfma_f32_16x16x32_bf16 v[180:183], v[44:47], v[68:71], v[180:183]
    s_cmp_ge_u32 s34, 147456
    s_cselect_b32 s34, 0, s34
    v_mfma_f32_16x16x32_bf16 v[184:187], v[44:47], v[72:75], v[184:187]
    v_mfma_f32_16x16x32_bf16 v[188:191], v[44:47], v[76:79], v[188:191]
    v_mfma_f32_16x16x32_bf16 v[252:255], v[60:63], v[76:79], v[252:255]
    v_mfma_f32_16x16x32_bf16 v[248:251], v[60:63], v[72:75], v[248:251]
    v_mfma_f32_16x16x32_bf16 v[244:247], v[60:63], v[68:71], v[244:247]
    v_mfma_f32_16x16x32_bf16 v[240:243], v[60:63], v[64:67], v[240:243]
    s_waitcnt lgkmcnt(0)
    v_mfma_f32_16x16x32_bf16 v[128:131], v[80:83], v[112:115], v[128:131]
    s_add_u32 m0, m0, 16
    s_mov_b64 exec, 1
    buffer_load_dword off, s[24:27], s26 lds
    s_mov_b64 exec, -1
    v_mfma_f32_16x16x32_bf16 v[132:135], v[80:83], v[116:119], v[132:135]
    v_or_b32 v14, v14, v15
    v_add_u32 v3, s34, v2
    v_mfma_f32_16x16x32_bf16 v[136:139], v[80:83], v[120:123], v[136:139]
    v_cmp_ne_u32 vcc, 0, v14
    v_add_u32 v7, s34, v6
    v_mfma_f32_16x16x32_bf16 v[140:143], v[80:83], v[124:127], v[140:143]
    s_cbranch_vccnz LG1w1
LG1r1:
    v_mfma_f32_16x16x32_bf16 v[204:207], v[96:99], v[124:127], v[204:207]
    ds_read_b64_tr_b16 v[32:33], v7 offset:0
    v_xor_b32 v4, 64, v3
    v_mfma_f32_16x16x32_bf16 v[200:203], v[96:99], v[120:123], v[200:203]
    ds_read_b64_tr_b16 v[34:35], v7 offset:1024
    v_xor_b32_e64 v8, 32, v7
    v_mfma_f32_16x16x32_bf16 v[196:199], v[96:99], v[116:119], v[196:199]
    ds_read_b128 v[64:67], v3 offset:0
    v_xor_b32_e64 v9, 64, v7
    v_mfma_f32_16x16x32_bf16 v[192:195], v[96:99], v[112:115], v[192:195]
    ds_read_b128 v[68:71], v3 offset:2048
    v_xor_b32 v10, 96, v7
    v_mfma_f32_16x16x32_bf16 v[144:147], v[84:87], v[112:115], v[144:147]
    ds_read_b128 v[72:75], v3 offset:4096
    v_mfma_f32_16x16x32_bf16 v[148:151], v[84:87], v[116:119], v[148:151]
    ds_read_b128 v[76:79], v3 offset:6144
    v_mfma_f32_16x16x32_bf16 v[152:155], v[84:87], v[120:123], v[152:155]
    ds_read_b64_tr_b16 v[48:49], v7 offset:16384
    v_mfma_f32_16x16x32_bf16 v[156:159], v[84:87], v[124:127], v[156:159]
    ds_read_b64_tr_b16 v[50:51], v7 offset:17408
    v_mfma_f32_16x16x32_bf16 v[220:223], v[100:103], v[124:127], v[220:223]
    ds_read_b64_tr_b16 v[36:37], v8 offset:0
    v_mfma_f32_16x16x32_bf16 v[216:219], v[100:103], v[120:123], v[216:219]
    ds_read_b64_tr_b16 v[38:39], v8 offset:1024
    v_mfma_f32_16x16x32_bf16 v[212:215], v[100:103], v[116:119], v[212:215]
    ds_read_b64_tr_b16 v[52:53], v8 offset:16384
    v_mfma_f32_16x16x32_bf16 v[208:211], v[100:103], v[112:115], v[208:211]
    ds_read_b64_tr_b16 v[54:55], v8 offset:17408
    v_mfma_f32_16x16x32_bf16 v[160:163], v[88:91], v[112:115], v[160:163]
    ds_read_b64_tr_b16 v[40:41], v9 offset:0
    v_mfma_f32_16x16x32_bf16 v[164:167], v[88:91], v[116:119], v[164:167]
    ds_read_b64_tr_b16 v[42:43], v9 offset:1024
    v_mfma_f32_16x16x32_bf16 v[168:171], v[88:91], v[120:123], v[168:171]
    ds_read_b64_tr_b16 v[56:57], v9 offset:16384
    v_mfma_f32_16x16x32_bf16 v[172:175], v[88:91], v[124:127], v[172:175]
    ds_read_b64_tr_b16 v[58:59], v9 offset:17408
    v_mfma_f32_16x16x32_bf16 v[236:239], v[104:107], v[124:127], v[236:239]
    ds_read_b64_tr_b16 v[44:45], v10 offset:0
    v_mfma_f32_16x16x32_bf16 v[232:235], v[104:107], v[120:123], v[232:235]
    ds_read_b64_tr_b16 v[46:47], v10 offset:1024
    v_mfma_f32_16x16x32_bf16 v[228:231], v[104:107], v[116:119], v[228:231]
    ds_read_b64_tr_b16 v[60:61], v10 offset:16384
    v_mfma_f32_16x16x32_bf16 v[224:227], v[104:107], v[112:115], v[224:227]
    ds_read_b64_tr_b16 v[62:63], v10 offset:17408
    v_mfma_f32_16x16x32_bf16 v[176:179], v[92:95], v[112:115], v[176:179]
    ds_read_b64 v[14:15], v11 offset:24
    v_mfma_f32_16x16x32_bf16 v[180:183], v[92:95], v[116:119], v[180:183]
    v_add_u32 v11, 16, v11
    s_cmp_lt_u32 s33, 18
    v_mfma_f32_16x16x32_bf16 v[184:187], v[92:95], v[120:123], v[184:187]
    v_mfma_f32_16x16x32_bf16 v[188:191], v[92:95], v[124:127], v[188:191]
    v_mfma_f32_16x16x32_bf16 v[252:255], v[108:111], v[124:127], v[252:255]
    v_mfma_f32_16x16x32_bf16 v[248:251], v[108:111], v[120:123], v[248:251]
    v_mfma_f32_16x16x32_bf16 v[244:247], v[108:111], v[116:119], v[244:247]
    v_mfma_f32_16x16x32_bf16 v[240:243], v[108:111], v[112:115], v[240:243]
    s_cbranch_scc1 LG1loop
    s_waitcnt lgkmcnt(0)
    v_mfma_f32_16x16x32_bf16 v[128:131], v[32:35], v[64:67], v[128:131]
    v_or_b32 v14, v14, v15
    v_mfma_f32_16x16x32_bf16 v[132:135], v[32:35], v[68:71], v[132:135]
    v_cmp_ne_u32 vcc, 0, v14
    v_mfma_f32_16x16x32_bf16 v[136:139], v[32:35], v[72:75], v[136:139]
    s_cbranch_vccnz LG1w0L
LG1r0L:
    s_nop 0
    v_mfma_f32_16x16x32_bf16 v[140:143], v[32:35], v[76:79], v[140:143]
    ds_read_b64_tr_b16 v[80:81], v7 offset:8192
    v_mfma_f32_16x16x32_bf16 v[204:207], v[48:51], v[76:79], v[204:207]
    ds_read_b64_tr_b16 v[82:83], v7 offset:9216
    v_mfma_f32_16x16x32_bf16 v[200:203], v[48:51], v[72:75], v[200:203]
    ds_read_b128 v[112:115], v4 offset:0
    v_mfma_f32_16x16x32_bf16 v[196:199], v[48:51], v[68:71], v[196:199]
    ds_read_b128 v[116:119], v4 offset:2048
    v_mfma_f32_16x16x32_bf16 v[192:195], v[48:51], v[64:67], v[192:195]
    ds_read_b128 v[120:123], v4 offset:4096
    v_mfma_f32_16x16x32_bf16 v[144:147], v[36:39], v[64:67], v[144:147]
    ds_read_b128 v[124:127], v4 offset:6144
    v_mfma_f32_16x16x32_bf16 v[148:151], v[36:39], v[68:71], v[148:151]
    ds_read_b64_tr_b16 v[96:97], v7 offset:24576
    v_mfma_f32_16x16x32_bf16 v[152:155], v[36:39], v[72:75], v[152:155]
    ds_read_b64_tr_b16 v[98:99], v7 offset:25600
    v_mfma_f32_16x16x32_bf16 v[156:159], v[36:39], v[76:79], v[156:159]
    ds_read_b64_tr_b16 v[84:85], v8 offset:8192
    v_mfma_f32_16x16x32_bf16 v[220:223], v[52:55], v[76:79], v[220:223]
    ds_read_b64_tr_b16 v[86:87], v8 offset:9216
    v_mfma_f32_16x16x32_bf16 v[216:219], v[52:55], v[72:75], v[216:219]
    ds_read_b64_tr_b16 v[100:101], v8 offset:24576
    v_mfma_f32_16x16x32_bf16 v[212:215], v[52:55], v[68:71], v[212:215]
    ds_read_b64_tr_b16 v[102:103], v8 offset:25600
    v_mfma_f32_16x16x32_bf16 v[208:211], v[52:55], v[64:67], v[208:211]
    ds_read_b64_tr_b16 v[88:89], v9 offset:8192
    v_mfma_f32_16x16x32_bf16 v[160:163], v[40:43], v[64:67], v[160:163]
    ds_read_b64_tr_b16 v[90:91], v9 offset:9216
    v_mfma_f32_16x16x32_bf16 v[164:167], v[40:43], v[68:71], v[164:167]
    ds_read_b64_tr_b16 v[104:105], v9 offset:24576
    v_mfma_f32_16x16x32_bf16 v[168:171], v[40:43], v[72:75], v[168:171]
    ds_read_b64_tr_b16 v[106:107], v9 offset:25600
    v_mfma_f32_16x16x32_bf16 v[172:175], v[40:43], v[76:79], v[172:175]
    ds_read_b64_tr_b16 v[92:93], v10 offset:8192
    v_mfma_f32_16x16x32_bf16 v[236:239], v[56:59], v[76:79], v[236:239]
    ds_read_b64_tr_b16 v[94:95], v10 offset:9216
    v_mfma_f32_16x16x32_bf16 v[232:235], v[56:59], v[72:75], v[232:235]
    ds_read_b64_tr_b16 v[108:109], v10 offset:24576
    v_mfma_f32_16x16x32_bf16 v[228:231], v[56:59], v[68:71], v[228:231]
    ds_read_b64_tr_b16 v[110:111], v10 offset:25600
    v_mfma_f32_16x16x32_bf16 v[224:227], v[56:59], v[64:67], v[224:227]
    ds_read_b32 v14, v13 offset:404
    v_mfma_f32_16x16x32_bf16 v[176:179], v[44:47], v[64:67], v[176:179]
    v_mfma_f32_16x16x32_bf16 v[180:183], v[44:47], v[68:71], v[180:183]
    v_mfma_f32_16x16x32_bf16 v[184:187], v[44:47], v[72:75], v[184:187]
    v_mfma_f32_16x16x32_bf16 v[188:191], v[44:47], v[76:79], v[188:191]
    v_mfma_f32_16x16x32_bf16 v[252:255], v[60:63], v[76:79], v[252:255]
    v_mfma_f32_16x16x32_bf16 v[248:251], v[60:63], v[72:75], v[248:251]
    v_mfma_f32_16x16x32_bf16 v[244:247], v[60:63], v[68:71], v[244:247]
    v_mfma_f32_16x16x32_bf16 v[240:243], v[60:63], v[64:67], v[240:243]
    s_waitcnt lgkmcnt(0)
    v_mfma_f32_16x16x32_bf16 v[128:131], v[80:83], v[112:115], v[128:131]
    s_add_u32 m0, m0, 16
    s_mov_b64 exec, 1
    buffer_load_dword off, s[24:27], s26 lds
    s_mov_b64 exec, -1
    v_cmp_eq_u32 vcc, 0, v14
    v_mfma_f32_16x16x32_bf16 v[132:135], v[80:83], v[116:119], v[132:135]
    s_cbranch_vccnz LG1ww
LG1wr:
    v_mfma_f32_16x16x32_bf16 v[136:139], v[80:83], v[120:123], v[136:139]
    v_bfe_u32 v16, v0, 4, 1
    v_mul_u32_u24 v16, 49152, v16
    v_mfma_f32_16x16x32_bf16 v[140:143], v[80:83], v[124:127], v[140:143]
    v_lshrrev_b32_e64 v17, 5, v0
    v_lshl_add_u32 v16, v17, 8, v16
    v_mfma_f32_16x16x32_bf16 v[204:207], v[96:99], v[124:127], v[204:207]
    v_and_b32_e64 v17, 15, v0
    v_lshl_add_u32 v16, v17, 4, v16
    v_mfma_f32_16x16x32_bf16 v[200:203], v[96:99], v[120:123], v[200:203]
    s_lshl_b32 s4, s28, 3
    s_lshl_b32 s5, s8, 2
    v_mfma_f32_16x16x32_bf16 v[196:199], v[96:99], v[116:119], v[196:199]
    s_add_u32 s4, s4, s5
    s_mul_i32 s4, s4, 49152
    v_mfma_f32_16x16x32_bf16 v[192:195], v[96:99], v[112:115], v[192:195]
    s_lshl_b32 s5, s29, 12
    s_lshl_b32 s6, s9, 11
    v_mfma_f32_16x16x32_bf16 v[144:147], v[84:87], v[112:115], v[144:147]
    s_add_u32 s5, s5, s6
    s_add_u32 s4, s4, s5
    v_mfma_f32_16x16x32_bf16 v[148:151], v[84:87], v[116:119], v[148:151]
    s_add_u32 s10, s4, 7340032
    s_add_u32 s11, s10, 98304
    v_mfma_f32_16x16x32_bf16 v[152:155], v[84:87], v[120:123], v[152:155]
    s_mov_b32 s12, 0xbfb8aa3b
    s_mov_b32 s13, s12
    v_mfma_f32_16x16x32_bf16 v[156:159], v[84:87], v[124:127], v[156:159]
    v_mfma_f32_16x16x32_bf16 v[220:223], v[100:103], v[124:127], v[220:223]
    v_mfma_f32_16x16x32_bf16 v[216:219], v[100:103], v[120:123], v[216:219]
    v_mfma_f32_16x16x32_bf16 v[212:215], v[100:103], v[116:119], v[212:215]
    v_mfma_f32_16x16x32_bf16 v[208:211], v[100:103], v[112:115], v[208:211]
    v_mfma_f32_16x16x32_bf16 v[160:163], v[88:91], v[112:115], v[160:163]
    v_mfma_f32_16x16x32_bf16 v[164:167], v[88:91], v[116:119], v[164:167]
    v_mfma_f32_16x16x32_bf16 v[168:171], v[88:91], v[120:123], v[168:171]
    v_mfma_f32_16x16x32_bf16 v[172:175], v[88:91], v[124:127], v[172:175]
    v_mfma_f32_16x16x32_bf16 v[236:239], v[104:107], v[124:127], v[236:239]
    v_mfma_f32_16x16x32_bf16 v[232:235], v[104:107], v[120:123], v[232:235]
    v_mfma_f32_16x16x32_bf16 v[228:231], v[104:107], v[116:119], v[228:231]
    v_mfma_f32_16x16x32_bf16 v[224:227], v[104:107], v[112:115], v[224:227]
    v_mfma_f32_16x16x32_bf16 v[176:179], v[92:95], v[112:115], v[176:179]
    v_mfma_f32_16x16x32_bf16 v[180:183], v[92:95], v[116:119], v[180:183]
    v_mfma_f32_16x16x32_bf16 v[184:187], v[92:95], v[120:123], v[184:187]
    v_mfma_f32_16x16x32_bf16 v[188:191], v[92:95], v[124:127], v[188:191]
    v_mfma_f32_16x16x32_bf16 v[252:255], v[108:111], v[124:127], v[252:255]
    v_mfma_f32_16x16x32_bf16 v[248:251], v[108:111], v[120:123], v[248:251]
    v_mfma_f32_16x16x32_bf16 v[244:247], v[108:111], v[116:119], v[244:247]
    v_mfma_f32_16x16x32_bf16 v[240:243], v[108:111], v[112:115], v[240:243]
    v_pk_mul_f32 v[80:81], v[128:129], s[12:13]
    v_pk_mul_f32 v[82:83], v[130:131], s[12:13]
    v_pk_mul_f32 v[84:85], v[132:133], s[12:13]
    v_pk_mul_f32 v[86:87], v[134:135], s[12:13]
    v_exp_f32 v80, v80
    v_exp_f32 v81, v81
    v_exp_f32 v82, v82
    v_exp_f32 v83, v83
    v_exp_f32 v84, v84
    v_exp_f32 v85, v85
    v_exp_f32 v86, v86
    v_exp_f32 v87, v87
    v_pk_mul_f32 v[128:129], v[128:129], v[192:193]
    v_pk_mul_f32 v[130:131], v[130:131], v[194:195]
    v_pk_mul_f32 v[132:133], v[132:133], v[196:197]
    v_pk_mul_f32 v[134:135], v[134:135], v[198:199]
    v_pk_add_f32 v[80:81], v[80:81], 1.0 op_sel_hi:[1,0]
    v_pk_add_f32 v[82:83], v[82:83], 1.0 op_sel_hi:[1,0]
    v_pk_add_f32 v[84:85], v[84:85], 1.0 op_sel_hi:[1,0]
    v_pk_add_f32 v[86:87], v[86:87], 1.0 op_sel_hi:[1,0]
    v_rcp_f32 v80, v80
    v_rcp_f32 v81, v81
    v_rcp_f32 v82, v82
    v_rcp_f32 v83, v83
    v_rcp_f32 v84, v84
    v_rcp_f32 v85, v85
    v_rcp_f32 v86, v86
    v_rcp_f32 v87, v87
    v_pk_mul_f32 v[128:129], v[128:129], v[80:81]
    v_pk_mul_f32 v[130:131], v[130:131], v[82:83]
    v_pk_mul_f32 v[132:133], v[132:133], v[84:85]
    v_pk_mul_f32 v[134:135], v[134:135], v[86:87]
    v_cvt_pk_bf16_f32 v88, v128, v129
    v_cvt_pk_bf16_f32 v89, v130, v131
    v_cvt_pk_bf16_f32 v90, v132, v133
    v_cvt_pk_bf16_f32 v91, v134, v135
    s_nop 0
    v_permlane16_swap_b32 v88, v90
    v_permlane16_swap_b32 v89, v91
    buffer_store_dwordx4 v[88:91], v16, s[20:23], s10 offen offset:0 sc1
    v_pk_mul_f32 v[96:97], v[136:137], s[12:13]
    v_pk_mul_f32 v[98:99], v[138:139], s[12:13]
    v_pk_mul_f32 v[100:101], v[140:141], s[12:13]
    v_pk_mul_f32 v[102:103], v[142:143], s[12:13]
    v_exp_f32 v96, v96
    v_exp_f32 v97, v97
    v_exp_f32 v98, v98
    v_exp_f32 v99, v99
    v_exp_f32 v100, v100
    v_exp_f32 v101, v101
    v_exp_f32 v102, v102
    v_exp_f32_e64 v103, v103
    v_pk_mul_f32 v[136:137], v[136:137], v[200:201]
    v_pk_mul_f32 v[138:139], v[138:139], v[202:203]
    v_pk_mul_f32 v[140:141], v[140:141], v[204:205]
    v_pk_mul_f32 v[142:143], v[142:143], v[206:207]
    v_pk_add_f32 v[96:97], v[96:97], 1.0 op_sel_hi:[1,0]
    v_pk_add_f32 v[98:99], v[98:99], 1.0 op_sel_hi:[1,0]
    v_pk_add_f32 v[100:101], v[100:101], 1.0 op_sel_hi:[1,0]
    v_pk_add_f32 v[102:103], v[102:103], 1.0 op_sel_hi:[1,0]
    v_rcp_f32 v96, v96
    v_rcp_f32 v97, v97
    v_rcp_f32 v98, v98
    v_rcp_f32 v99, v99
    v_rcp_f32 v100, v100
    v_rcp_f32 v101, v101
    v_rcp_f32 v102, v102
    v_rcp_f32 v103, v103
    v_pk_mul_f32 v[136:137], v[136:137], v[96:97]
    v_pk_mul_f32 v[138:139], v[138:139], v[98:99]
    v_pk_mul_f32 v[140:141], v[140:141], v[100:101]
    v_pk_mul_f32 v[142:143], v[142:143], v[102:103]
    v_cvt_pk_bf16_f32 v104, v136, v137
    v_cvt_pk_bf16_f32 v105, v138, v139
    v_cvt_pk_bf16_f32 v106, v140, v141
    v_cvt_pk_bf16_f32 v107, v142, v143
    s_nop 0
    v_permlane16_swap_b32 v104, v106
    v_permlane16_swap_b32 v105, v107
    buffer_store_dwordx4 v[104:107], v16, s[20:23], s11 offen offset:0 sc1
    v_pk_mul_f32 v[80:81], v[144:145], s[12:13]
    v_pk_mul_f32 v[82:83], v[146:147], s[12:13]
    v_pk_mul_f32 v[84:85], v[148:149], s[12:13]
    v_pk_mul_f32 v[86:87], v[150:151], s[12:13]
    v_exp_f32 v80, v80
    v_exp_f32 v81, v81
    v_exp_f32 v82, v82
    v_exp_f32 v83, v83
    v_exp_f32 v84, v84
    v_exp_f32 v85, v85
    v_exp_f32 v86, v86
    v_exp_f32_e64 v87, v87
    v_pk_mul_f32 v[144:145], v[144:145], v[208:209]
    v_pk_mul_f32 v[146:147], v[146:147], v[210:211]
    v_pk_mul_f32 v[148:149], v[148:149], v[212:213]
    v_pk_mul_f32 v[150:151], v[150:151], v[214:215]
    v_pk_add_f32 v[80:81], v[80:81], 1.0 op_sel_hi:[1,0]
    v_pk_add_f32 v[82:83], v[82:83], 1.0 op_sel_hi:[1,0]
    v_pk_add_f32 v[84:85], v[84:85], 1.0 op_sel_hi:[1,0]
    v_pk_add_f32 v[86:87], v[86:87], 1.0 op_sel_hi:[1,0]
    v_rcp_f32 v80, v80
    v_rcp_f32 v81, v81
    v_rcp_f32 v82, v82
    v_rcp_f32 v83, v83
    v_rcp_f32 v84, v84
    v_rcp_f32 v85, v85
    v_rcp_f32 v86, v86
    v_rcp_f32 v87, v87
    v_pk_mul_f32 v[144:145], v[144:145], v[80:81]
    v_pk_mul_f32 v[146:147], v[146:147], v[82:83]
    v_pk_mul_f32 v[148:149], v[148:149], v[84:85]
    v_pk_mul_f32 v[150:151], v[150:151], v[86:87]
    v_cvt_pk_bf16_f32 v88, v144, v145
    v_cvt_pk_bf16_f32 v89, v146, v147
    v_cvt_pk_bf16_f32 v90, v148, v149
    v_cvt_pk_bf16_f32 v91, v150, v151
    s_nop 0
    v_permlane16_swap_b32 v88, v90
    v_permlane16_swap_b32 v89, v91
    buffer_store_dwordx4 v[88:91], v16, s[20:23], s10 offen offset:512 sc1
    v_pk_mul_f32 v[96:97], v[152:153], s[12:13]
    v_pk_mul_f32 v[98:99], v[154:155], s[12:13]
    v_pk_mul_f32 v[100:101], v[156:157], s[12:13]
    v_pk_mul_f32 v[102:103], v[158:159], s[12:13]
    v_exp_f32 v96, v96
    v_exp_f32 v97, v97
    v_exp_f32 v98, v98
    v_exp_f32 v99, v99
    v_exp_f32 v100, v100
    v_exp_f32 v101, v101
    v_exp_f32 v102, v102
    v_exp_f32_e64 v103, v103
    v_pk_mul_f32 v[152:153], v[152:153], v[216:217]
    v_pk_mul_f32 v[154:155], v[154:155], v[218:219]
    v_pk_mul_f32 v[156:157], v[156:157], v[220:221]
    v_pk_mul_f32 v[158:159], v[158:159], v[222:223]
    v_pk_add_f32 v[96:97], v[96:97], 1.0 op_sel_hi:[1,0]
    v_pk_add_f32 v[98:99], v[98:99], 1.0 op_sel_hi:[1,0]
    v_pk_add_f32 v[100:101], v[100:101], 1.0 op_sel_hi:[1,0]
    v_pk_add_f32 v[102:103], v[102:103], 1.0 op_sel_hi:[1,0]
    v_rcp_f32 v96, v96
    v_rcp_f32 v97, v97
    v_rcp_f32 v98, v98
    v_rcp_f32 v99, v99
    v_rcp_f32 v100, v100
    v_rcp_f32 v101, v101
    v_rcp_f32 v102, v102
    v_rcp_f32 v103, v103
    v_pk_mul_f32 v[152:153], v[152:153], v[96:97]
    v_pk_mul_f32 v[154:155], v[154:155], v[98:99]
    v_pk_mul_f32 v[156:157], v[156:157], v[100:101]
    v_pk_mul_f32 v[158:159], v[158:159], v[102:103]
    v_cvt_pk_bf16_f32 v104, v152, v153
    v_cvt_pk_bf16_f32 v105, v154, v155
    v_cvt_pk_bf16_f32 v106, v156, v157
    v_cvt_pk_bf16_f32 v107, v158, v159
    s_nop 0
    v_permlane16_swap_b32 v104, v106
    v_permlane16_swap_b32 v105, v107
    buffer_store_dwordx4 v[104:107], v16, s[20:23], s11 offen offset:512 sc1
    v_pk_mul_f32 v[80:81], v[160:161], s[12:13]
    v_pk_mul_f32 v[82:83], v[162:163], s[12:13]
    v_pk_mul_f32 v[84:85], v[164:165], s[12:13]
    v_pk_mul_f32 v[86:87], v[166:167], s[12:13]
    v_exp_f32 v80, v80
    v_exp_f32 v81, v81
    v_exp_f32 v82, v82
    v_exp_f32 v83, v83
    v_exp_f32 v84, v84
    v_exp_f32 v85, v85
    v_exp_f32 v86, v86
    v_exp_f32_e64 v87, v87
    v_pk_mul_f32 v[160:161], v[160:161], v[224:225]
    v_pk_mul_f32 v[162:163], v[162:163], v[226:227]
    v_pk_mul_f32 v[164:165], v[164:165], v[228:229]
    v_pk_mul_f32 v[166:167], v[166:167], v[230:231]
    v_pk_add_f32 v[80:81], v[80:81], 1.0 op_sel_hi:[1,0]
    v_pk_add_f32 v[82:83], v[82:83], 1.0 op_sel_hi:[1,0]
    v_pk_add_f32 v[84:85], v[84:85], 1.0 op_sel_hi:[1,0]
    v_pk_add_f32 v[86:87], v[86:87], 1.0 op_sel_hi:[1,0]
    v_rcp_f32 v80, v80
    v_rcp_f32 v81, v81
    v_rcp_f32 v82, v82
    v_rcp_f32 v83, v83
    v_rcp_f32 v84, v84
    v_rcp_f32 v85, v85
    v_rcp_f32 v86, v86
    v_rcp_f32 v87, v87
    v_pk_mul_f32 v[160:161], v[160:161], v[80:81]
    v_pk_mul_f32 v[162:163], v[162:163], v[82:83]
    v_pk_mul_f32 v[164:165], v[164:165], v[84:85]
    v_pk_mul_f32 v[166:167], v[166:167], v[86:87]
    v_cvt_pk_bf16_f32 v88, v160, v161
    v_cvt_pk_bf16_f32 v89, v162, v163
    v_cvt_pk_bf16_f32 v90, v164, v165
    v_cvt_pk_bf16_f32 v91, v166, v167
    s_nop 0
    v_permlane16_swap_b32 v88, v90
    v_permlane16_swap_b32 v89, v91
    buffer_store_dwordx4 v[88:91], v16, s[20:23], s10 offen offset:1024 sc1
    v_pk_mul_f32 v[96:97], v[168:169], s[12:13]
    v_pk_mul_f32 v[98:99], v[170:171], s[12:13]
    v_pk_mul_f32 v[100:101], v[172:173], s[12:13]
    v_pk_mul_f32 v[102:103], v[174:175], s[12:13]
    v_exp_f32 v96, v96
    v_exp_f32 v97, v97
    v_exp_f32 v98, v98
    v_exp_f32 v99, v99
    v_exp_f32 v100, v100
    v_exp_f32 v101, v101
    v_exp_f32 v102, v102
    v_exp_f32_e64 v103, v103
    v_pk_mul_f32 v[168:169], v[168:169], v[232:233]
    v_pk_mul_f32 v[170:171], v[170:171], v[234:235]
    v_pk_mul_f32 v[172:173], v[172:173], v[236:237]
    v_pk_mul_f32 v[174:175], v[174:175], v[238:239]
    v_pk_add_f32 v[96:97], v[96:97], 1.0 op_sel_hi:[1,0]
    v_pk_add_f32 v[98:99], v[98:99], 1.0 op_sel_hi:[1,0]
    v_pk_add_f32 v[100:101], v[100:101], 1.0 op_sel_hi:[1,0]
    v_pk_add_f32 v[102:103], v[102:103], 1.0 op_sel_hi:[1,0]
    v_rcp_f32 v96, v96
    v_rcp_f32 v97, v97
    v_rcp_f32 v98, v98
    v_rcp_f32 v99, v99
    v_rcp_f32 v100, v100
    v_rcp_f32 v101, v101
    v_rcp_f32 v102, v102
    v_rcp_f32 v103, v103
    v_pk_mul_f32 v[168:169], v[168:169], v[96:97]
    v_pk_mul_f32 v[170:171], v[170:171], v[98:99]
    v_pk_mul_f32 v[172:173], v[172:173], v[100:101]
    v_pk_mul_f32 v[174:175], v[174:175], v[102:103]
    v_cvt_pk_bf16_f32 v104, v168, v169
    v_cvt_pk_bf16_f32 v105, v170, v171
    v_cvt_pk_bf16_f32 v106, v172, v173
    v_cvt_pk_bf16_f32 v107, v174, v175
    s_nop 0
    v_permlane16_swap_b32 v104, v106
    v_permlane16_swap_b32 v105, v107
    buffer_store_dwordx4 v[104:107], v16, s[20:23], s11 offen offset:1024 sc1
    v_pk_mul_f32 v[80:81], v[176:177], s[12:13]
    v_pk_mul_f32 v[82:83], v[178:179], s[12:13]
    v_pk_mul_f32 v[84:85], v[180:181], s[12:13]
    v_pk_mul_f32 v[86:87], v[182:183], s[12:13]
    v_exp_f32 v80, v80
    v_exp_f32 v81, v81
    v_exp_f32 v82, v82
    v_exp_f32 v83, v83
    v_exp_f32 v84, v84
    v_exp_f32 v85, v85
    v_exp_f32 v86, v86
    v_exp_f32_e64 v87, v87
    v_pk_mul_f32 v[176:177], v[176:177], v[240:241]
    v_pk_mul_f32 v[178:179], v[178:179], v[242:243]
    v_pk_mul_f32 v[180:181], v[180:181], v[244:245]
    v_pk_mul_f32 v[182:183], v[182:183], v[246:247]
    v_pk_add_f32 v[80:81], v[80:81], 1.0 op_sel_hi:[1,0]
    v_pk_add_f32 v[82:83], v[82:83], 1.0 op_sel_hi:[1,0]
    v_pk_add_f32 v[84:85], v[84:85], 1.0 op_sel_hi:[1,0]
    v_pk_add_f32 v[86:87], v[86:87], 1.0 op_sel_hi:[1,0]
    v_rcp_f32 v80, v80
    v_rcp_f32 v81, v81
    v_rcp_f32 v82, v82
    v_rcp_f32 v83, v83
    v_rcp_f32 v84, v84
    v_rcp_f32 v85, v85
    v_rcp_f32 v86, v86
    v_rcp_f32 v87, v87
    v_pk_mul_f32 v[176:177], v[176:177], v[80:81]
    v_pk_mul_f32 v[178:179], v[178:179], v[82:83]
    v_pk_mul_f32 v[180:181], v[180:181], v[84:85]
    v_pk_mul_f32 v[182:183], v[182:183], v[86:87]
    v_cvt_pk_bf16_f32 v88, v176, v177
    v_cvt_pk_bf16_f32 v89, v178, v179
    v_cvt_pk_bf16_f32 v90, v180, v181
    v_cvt_pk_bf16_f32 v91, v182, v183
    s_nop 0
    v_permlane16_swap_b32 v88, v90
    v_permlane16_swap_b32 v89, v91
    buffer_store_dwordx4 v[88:91], v16, s[20:23], s10 offen offset:1536 sc1
    v_pk_mul_f32 v[96:97], v[184:185], s[12:13]
    v_pk_mul_f32 v[98:99], v[186:187], s[12:13]
    v_pk_mul_f32 v[100:101], v[188:189], s[12:13]
    v_pk_mul_f32 v[102:103], v[190:191], s[12:13]
    v_exp_f32 v96, v96
    v_exp_f32 v97, v97
    v_exp_f32 v98, v98
    v_exp_f32 v99, v99
    v_exp_f32 v100, v100
    v_exp_f32 v101, v101
    v_exp_f32 v102, v102
    v_exp_f32_e64 v103, v103
    v_pk_mul_f32 v[184:185], v[184:185], v[248:249]
    v_pk_mul_f32 v[186:187], v[186:187], v[250:251]
    v_pk_mul_f32 v[188:189], v[188:189], v[252:253]
    v_pk_mul_f32 v[190:191], v[190:191], v[254:255]
    v_pk_add_f32 v[96:97], v[96:97], 1.0 op_sel_hi:[1,0]
    v_pk_add_f32 v[98:99], v[98:99], 1.0 op_sel_hi:[1,0]
    v_pk_add_f32 v[100:101], v[100:101], 1.0 op_sel_hi:[1,0]
    v_pk_add_f32 v[102:103], v[102:103], 1.0 op_sel_hi:[1,0]
    v_rcp_f32 v96, v96
    v_rcp_f32 v97, v97
    v_rcp_f32 v98, v98
    v_rcp_f32 v99, v99
    v_rcp_f32 v100, v100
    v_rcp_f32 v101, v101
    v_rcp_f32 v102, v102
    v_rcp_f32 v103, v103
    v_pk_mul_f32 v[184:185], v[184:185], v[96:97]
    v_pk_mul_f32 v[186:187], v[186:187], v[98:99]
    v_pk_mul_f32 v[188:189], v[188:189], v[100:101]
    v_pk_mul_f32 v[190:191], v[190:191], v[102:103]
    v_cvt_pk_bf16_f32 v104, v184, v185
    v_cvt_pk_bf16_f32 v105, v186, v187
    v_cvt_pk_bf16_f32 v106, v188, v189
    v_cvt_pk_bf16_f32 v107, v190, v191
    s_nop 0
    v_permlane16_swap_b32 v104, v106
    v_permlane16_swap_b32 v105, v107
    buffer_store_dwordx4 v[104:107], v16, s[20:23], s11 offen offset:1536 sc1
    v_mov_b32 v17, 0
    v_lshl_add_u32 v18, s3, 2, v13
    s_mov_b64 exec, 1
    ds_write_b32 v18, v17 offset:320
    s_mov_b64 exec, -1
    s_lshl_b32 s6, s28, 1
    s_add_u32 s6, s6, s8
    s_lshl_b32 s6, s6, 2
    s_and_b32 s7, s66, 3
    s_add_u32 s6, s6, s7
    s_waitcnt vmcnt(0)
    s_lshl_b32 s4, s6, 7
    v_mov_b32 v16, s4
    v_mov_b32 v17, 1
    s_mov_b64 exec, 1
    buffer_atomic_add v17, v16, s[20:23], 0 offen sc1
    s_mov_b64 exec, -1
LG2:
    s_nop 0
    buffer_load_dwordx4 v[20:23], v5, s[20:23], s18 offen offset:0 sc1
    buffer_load_dwordx4 v[24:27], v5, s[20:23], s18 offen offset:1024 sc1
    buffer_load_dwordx4 v[28:31], v5, s[20:23], s18 offen offset:2048 sc1
    buffer_load_dwordx4 v[32:35], v5, s[20:23], s18 offen offset:3072 sc1
    s_add_u32 s18, s18, 4096
    buffer_load_dwordx4 v[36:39], v5, s[20:23], s18 offen offset:0 sc1
    buffer_load_dwordx4 v[40:43], v5, s[20:23], s18 offen offset:1024 sc1
    buffer_load_dwordx4 v[44:47], v5, s[20:23], s18 offen offset:2048 sc1
    buffer_load_dwordx4 v[48:51], v5, s[20:23], s18 offen offset:3072 sc1
    s_add_u32 s18, s18, 4096
    buffer_load_dwordx4 v[52:55], v5, s[20:23], s18 offen offset:0 sc1
    buffer_load_dwordx4 v[56:59], v5, s[20:23], s18 offen offset:1024 sc1
    buffer_load_dwordx4 v[60:63], v5, s[20:23], s18 offen offset:2048 sc1
    buffer_load_dwordx4 v[64:67], v5, s[20:23], s18 offen offset:3072 sc1
    s_add_u32 s18, s18, 4096
    buffer_load_dwordx4 v[68:71], v5, s[20:23], s18 offen offset:0 sc1
    buffer_load_dwordx4 v[72:75], v5, s[20:23], s18 offen offset:1024 sc1
    buffer_load_dwordx4 v[76:79], v5, s[20:23], s18 offen offset:2048 sc1
LG2b:
    s_lshl_b32 s6, s31, 2
    s_add_u32 s6, s6, s3
    s_lshl_b32 s6, s6, 7
    v_mov_b32 v16, s6
    v_mov_b32_e64 v17, 6
    buffer_load_dwordx4 v[80:83], v5, s[20:23], s18 offen offset:3072 sc1
    s_add_u32 s18, s18, 4096
    buffer_load_dwordx4 v[84:87], v5, s[20:23], s18 offen offset:0 sc1
    buffer_load_dwordx4 v[88:91], v5, s[20:23], s18 offen offset:1024 sc1
    buffer_load_dwordx4 v[92:95], v5, s[20:23], s18 offen offset:2048 sc1
    buffer_load_dwordx4 v[96:99], v5, s[20:23], s18 offen offset:3072 sc1
    s_add_u32 s18, s18, 4096
    buffer_load_dwordx4 v[100:103], v5, s[20:23], s18 offen offset:0 sc1
    buffer_load_dwordx4 v[104:107], v5, s[20:23], s18 offen offset:1024 sc1
    buffer_load_dwordx4 v[108:111], v5, s[20:23], s18 offen offset:2048 sc1
    buffer_load_dwordx4 v[112:115], v5, s[20:23], s18 offen offset:3072 sc1
    s_add_u32 s18, s18, 4096
    buffer_load_dwordx4 v[116:119], v5, s[20:23], s18 offen offset:0 sc1
    buffer_load_dwordx4 v[120:123], v5, s[20:23], s18 offen offset:1024 sc1
    buffer_load_dwordx4 v[124:127], v5, s[20:23], s18 offen offset:2048 sc1
    buffer_load_dwordx4 v[128:131], v5, s[20:23], s18 offen offset:3072 sc1
    s_add_u32 s18, s18, 4096
    buffer_load_dwordx4 v[132:135], v5, s[20:23], s18 offen offset:0 sc1
    buffer_load_dwordx4 v[136:139], v5, s[20:23], s18 offen offset:1024 sc1
    s_add_u32 s4, s3, 1
    s_and_b32 s4, s4, 3
    s_lshl_b32 s5, s31, 2
    s_add_u32 s4, s4, s5
    s_mul_i32 s4, s4, 49152
    s_mul_i32 s5, s3, 12288
    s_add_u32 s4, s4, s5
    s_add_u32 s8, s4, 7340032
    s_add_u32 s4, s3, 2
    s_and_b32 s4, s4, 3
    s_lshl_b32 s5, s31, 2
    s_add_u32 s4, s4, s5
    s_mul_i32 s4, s4, 49152
    s_mul_i32 s5, s3, 12288
    s_add_u32 s4, s4, s5
    s_add_u32 s9, s4, 7340032
    s_add_u32 s4, s3, 3
    s_and_b32 s4, s4, 3
    s_lshl_b32 s5, s31, 2
    s_add_u32 s4, s4, s5
    s_mul_i32 s4, s4, 49152
    s_mul_i32 s5, s3, 12288
    s_add_u32 s4, s4, s5
    s_add_u32 s10, s4, 7340032
    s_add_u32 s4, s3, 4
    s_and_b32 s4, s4, 3
    s_lshl_b32 s5, s31, 2
    s_add_u32 s4, s4, s5
    s_mul_i32 s4, s4, 49152
    s_mul_i32 s5, s3, 12288
    s_add_u32 s4, s4, s5
    s_add_u32 s11, s4, 7340032
    s_mul_i32 s4, s3, 30720
    v_add_u32 v3, s4, v5
    s_mov_b32 s5, 0
Lpl23:
    buffer_load_dword v18, v16, s[20:23], 0 offen sc1
    s_add_u32 s5, s5, 1
    s_waitcnt vmcnt(0)
    v_cmp_lt_u32 vcc, v18, v17
    s_cbranch_vccz Lple24
    s_sleep 1
    s_cmp_lt_u32 s5, 1048576
    s_cbranch_scc1 Lpl23
Lple24:
LG2go:
    buffer_load_dwordx4 v[140:143], v5, s[20:23], s8 offen offset:0 sc1
    buffer_load_dwordx4 v[144:147], v5, s[20:23], s9 offen offset:0 sc1
    buffer_load_dwordx4 v[148:151], v5, s[20:23], s10 offen offset:0 sc1
    buffer_load_dwordx4 v[152:155], v5, s[20:23], s11 offen offset:0 sc1
    buffer_load_dwordx4 v[156:159], v5, s[20:23], s8 offen offset:1024 sc1
    buffer_load_dwordx4 v[160:163], v5, s[20:23], s9 offen offset:1024 sc1
    buffer_load_dwordx4 v[164:167], v5, s[20:23], s10 offen offset:1024 sc1
    buffer_load_dwordx4 v[168:171], v5, s[20:23], s11 offen offset:1024 sc1
    s_sub_u32 s4, s3, 1
    s_and_b32 s4, s4, 3
    s_mul_i32 s4, s4, 30720
    v_add_u32 v8, s4, v5
    s_sub_u32 s4, s3, 2
    s_and_b32 s4, s4, 3
    s_mul_i32 s4, s4, 30720
    v_add_u32 v9, s4, v5
    s_sub_u32 s4, s3, 3
    s_and_b32 s4, s4, 3
    s_mul_i32 s4, s4, 30720
    v_add_u32 v10, s4, v5
    s_mov_b64 s[12:13], s[60:61]
    s_mov_b32 s14, 0x280000
    s_mov_b32 s15, 0x20000
    v_and_b32 v2, 15, v0
    s_lshl_b32 s5, s3, 4
    v_add_u32 v2, s5, v2
    v_lshlrev_b32 v6, 2, v2
    v_add_u32 v6, 133120, v6
    s_lshl_b32 s4, s31, 6
    v_add_u32 v2, s4, v2
    v_lshrrev_b32 v7, 4, v0
    v_bfe_u32 v12, v0, 2, 2
    v_lshlrev_b32 v11, 7, v12
    v_and_b32 v12, 3, v0
    v_lshl_add_u32 v11, v12, 3, v11
    s_lshl_b32 s4, s3, 5
    s_add_u32 s4, s4, 122880
    v_add_u32_e64 v11, s4, v11
    v_lshl_add_u32 v4, v7, 9, v11
    v_lshl_add_u32 v11, v7, 10, v11
    v_mul_u32_u24 v2, 1280, v2
    s_mul_i32 s4, s32, 160
    v_add_u32_e64 v2, s4, v2
    v_lshl_add_u32 v12, v7, 3, v2
    v_lshl_add_u32 v2, v7, 4, v2
    s_waitcnt vmcnt(7)
    v_mfma_f32_16x16x32_bf16 v[176:179], v[20:23], v[140:143], 0
    v_mfma_f32_16x16x32_bf16 v[180:183], v[24:27], v[140:143], 0
    v_mfma_f32_16x16x32_bf16 v[184:187], v[28:31], v[140:143], 0
    v_mfma_f32_16x16x32_bf16 v[188:191], v[32:35], v[140:143], 0
    v_mfma_f32_16x16x32_bf16 v[192:195], v[36:39], v[140:143], 0
    buffer_load_dwordx4 v[140:143], v5, s[20:23], s8 offen offset:2048 sc1
    s_waitcnt vmcnt(7)
    v_mfma_f32_16x16x32_bf16 v[212:215], v[36:39], v[144:147], 0
    v_mfma_f32_16x16x32_bf16 v[208:211], v[32:35], v[144:147], 0
    v_mfma_f32_16x16x32_bf16 v[204:207], v[28:31], v[144:147], 0
    v_mfma_f32_16x16x32_bf16 v[200:203], v[24:27], v[144:147], 0
    v_mfma_f32_16x16x32_bf16 v[196:199], v[20:23], v[144:147], 0
    buffer_load_dwordx4 v[144:147], v5, s[20:23], s9 offen offset:2048 sc1
    s_waitcnt vmcnt(7)
    v_mfma_f32_16x16x32_bf16 v[216:219], v[20:23], v[148:151], 0
    v_mfma_f32_16x16x32_bf16 v[220:223], v[24:27], v[148:151], 0
    v_mfma_f32_16x16x32_bf16 v[224:227], v[28:31], v[148:151], 0
    v_mfma_f32_16x16x32_bf16 v[228:231], v[32:35], v[148:151], 0
    v_mfma_f32_16x16x32_bf16 v[232:235], v[36:39], v[148:151], 0
    buffer_load_dwordx4 v[148:151], v5, s[20:23], s10 offen offset:2048 sc1
    s_waitcnt vmcnt(7)
    v_mfma_f32_16x16x32_bf16 v[252:255], v[36:39], v[152:155], 0
    v_mfma_f32_16x16x32_bf16 v[248:251], v[32:35], v[152:155], 0
    v_mfma_f32_16x16x32_bf16 v[244:247], v[28:31], v[152:155], 0
    v_mfma_f32_16x16x32_bf16 v[240:243], v[24:27], v[152:155], 0
    v_mfma_f32_16x16x32_bf16 v[236:239], v[20:23], v[152:155], 0
    buffer_load_dwordx4 v[152:155], v5, s[20:23], s11 offen offset:2048 sc1
    s_waitcnt vmcnt(7)
    v_mfma_f32_16x16x32_bf16 v[176:179], v[40:43], v[156:159], v[176:179]
    v_mfma_f32_16x16x32_bf16 v[180:183], v[44:47], v[156:159], v[180:183]
    v_mfma_f32_16x16x32_bf16 v[184:187], v[48:51], v[156:159], v[184:187]
    v_mfma_f32_16x16x32_bf16 v[188:191], v[52:55], v[156:159], v[188:191]
    v_mfma_f32_16x16x32_bf16 v[192:195], v[56:59], v[156:159], v[192:195]
    buffer_load_dwordx4 v[156:159], v5, s[20:23], s8 offen offset:3072 sc1
    s_add_u32 s8, s8, 4096
    s_waitcnt vmcnt(7)
    v_mfma_f32_16x16x32_bf16 v[212:215], v[56:59], v[160:163], v[212:215]
    v_mfma_f32_16x16x32_bf16 v[208:211], v[52:55], v[160:163], v[208:211]
    v_mfma_f32_16x16x32_bf16 v[204:207], v[48:51], v[160:163], v[204:207]
    v_mfma_f32_16x16x32_bf16 v[200:203], v[44:47], v[160:163], v[200:203]
    v_mfma_f32_16x16x32_bf16 v[196:199], v[40:43], v[160:163], v[196:199]
    buffer_load_dwordx4 v[160:163], v5, s[20:23], s9 offen offset:3072 sc1
    s_add_u32 s9, s9, 4096
    s_waitcnt vmcnt(7)
    v_mfma_f32_16x16x32_bf16 v[216:219], v[40:43], v[164:167], v[216:219]
    v_mfma_f32_16x16x32_bf16 v[220:223], v[44:47], v[164:167], v[220:223]
    v_mfma_f32_16x16x32_bf16 v[224:227], v[48:51], v[164:167], v[224:227]
    v_mfma_f32_16x16x32_bf16 v[228:231], v[52:55], v[164:167], v[228:231]
    v_mfma_f32_16x16x32_bf16 v[232:235], v[56:59], v[164:167], v[232:235]
    buffer_load_dwordx4 v[164:167], v5, s[20:23], s10 offen offset:3072 sc1
    s_add_u32 s10, s10, 4096
    s_waitcnt vmcnt(7)
    v_mfma_f32_16x16x32_bf16 v[252:255], v[56:59], v[168:171], v[252:255]
    v_mfma_f32_16x16x32_bf16 v[248:251], v[52:55], v[168:171], v[248:251]
    v_mfma_f32_16x16x32_bf16 v[244:247], v[48:51], v[168:171], v[244:247]
    v_mfma_f32_16x16x32_bf16 v[240:243], v[44:47], v[168:171], v[240:243]
    v_mfma_f32_16x16x32_bf16 v[236:239], v[40:43], v[168:171], v[236:239]
    buffer_load_dwordx4 v[168:171], v5, s[20:23], s11 offen offset:3072 sc1
    s_add_u32 s11, s11, 4096
    s_waitcnt vmcnt(7)
    v_mfma_f32_16x16x32_bf16 v[176:179], v[60:63], v[140:143], v[176:179]
    v_mfma_f32_16x16x32_bf16 v[180:183], v[64:67], v[140:143], v[180:183]
    v_mfma_f32_16x16x32_bf16 v[184:187], v[68:71], v[140:143], v[184:187]
    v_mfma_f32_16x16x32_bf16 v[188:191], v[72:75], v[140:143], v[188:191]
    v_mfma_f32_16x16x32_bf16 v[192:195], v[76:79], v[140:143], v[192:195]
    buffer_load_dwordx4 v[140:143], v5, s[20:23], s8 offen offset:0 sc1
    s_waitcnt vmcnt(7)
    v_mfma_f32_16x16x32_bf16 v[212:215], v[76:79], v[144:147], v[212:215]
    v_mfma_f32_16x16x32_bf16 v[208:211], v[72:75], v[144:147], v[208:211]
    v_mfma_f32_16x16x32_bf16 v[204:207], v[68:71], v[144:147], v[204:207]
    v_mfma_f32_16x16x32_bf16 v[200:203], v[64:67], v[144:147], v[200:203]
    v_mfma_f32_16x16x32_bf16 v[196:199], v[60:63], v[144:147], v[196:199]
    buffer_load_dwordx4 v[144:147], v5, s[20:23], s9 offen offset:0 sc1
    s_waitcnt vmcnt(7)
    v_mfma_f32_16x16x32_bf16 v[216:219], v[60:63], v[148:151], v[216:219]
    v_mfma_f32_16x16x32_bf16 v[220:223], v[64:67], v[148:151], v[220:223]
    v_mfma_f32_16x16x32_bf16 v[224:227], v[68:71], v[148:151], v[224:227]
    v_mfma_f32_16x16x32_bf16 v[228:231], v[72:75], v[148:151], v[228:231]
    v_mfma_f32_16x16x32_bf16 v[232:235], v[76:79], v[148:151], v[232:235]
    buffer_load_dwordx4 v[148:151], v5, s[20:23], s10 offen offset:0 sc1
    s_waitcnt vmcnt(7)
    v_mfma_f32_16x16x32_bf16 v[252:255], v[76:79], v[152:155], v[252:255]
    v_mfma_f32_16x16x32_bf16 v[248:251], v[72:75], v[152:155], v[248:251]
    v_mfma_f32_16x16x32_bf16 v[244:247], v[68:71], v[152:155], v[244:247]
    v_mfma_f32_16x16x32_bf16 v[240:243], v[64:67], v[152:155], v[240:243]
    v_mfma_f32_16x16x32_bf16 v[236:239], v[60:63], v[152:155], v[236:239]
    buffer_load_dwordx4 v[152:155], v5, s[20:23], s11 offen offset:0 sc1
    s_waitcnt vmcnt(7)
    v_mfma_f32_16x16x32_bf16 v[176:179], v[80:83], v[156:159], v[176:179]
    v_mfma_f32_16x16x32_bf16 v[180:183], v[84:87], v[156:159], v[180:183]
    v_mfma_f32_16x16x32_bf16 v[184:187], v[88:91], v[156:159], v[184:187]
    v_mfma_f32_16x16x32_bf16 v[188:191], v[92:95], v[156:159], v[188:191]
    v_mfma_f32_16x16x32_bf16 v[192:195], v[96:99], v[156:159], v[192:195]
    buffer_load_dwordx4 v[156:159], v5, s[20:23], s8 offen offset:1024 sc1
    s_waitcnt vmcnt(7)
    v_mfma_f32_16x16x32_bf16 v[212:215], v[96:99], v[160:163], v[212:215]
    v_mfma_f32_16x16x32_bf16 v[208:211], v[92:95], v[160:163], v[208:211]
    v_mfma_f32_16x16x32_bf16 v[204:207], v[88:91], v[160:163], v[204:207]
    v_mfma_f32_16x16x32_bf16 v[200:203], v[84:87], v[160:163], v[200:203]
    v_mfma_f32_16x16x32_bf16 v[196:199], v[80:83], v[160:163], v[196:199]
    buffer_load_dwordx4 v[160:163], v5, s[20:23], s9 offen offset:1024 sc1
    s_waitcnt vmcnt(7)
    v_mfma_f32_16x16x32_bf16 v[216:219], v[80:83], v[164:167], v[216:219]
    v_mfma_f32_16x16x32_bf16 v[220:223], v[84:87], v[164:167], v[220:223]
    v_mfma_f32_16x16x32_bf16 v[224:227], v[88:91], v[164:167], v[224:227]
    v_mfma_f32_16x16x32_bf16 v[228:231], v[92:95], v[164:167], v[228:231]
    v_mfma_f32_16x16x32_bf16 v[232:235], v[96:99], v[164:167], v[232:235]
    buffer_load_dwordx4 v[164:167], v5, s[20:23], s10 offen offset:1024 sc1
    s_waitcnt vmcnt(7)
    v_mfma_f32_16x16x32_bf16 v[252:255], v[96:99], v[168:171], v[252:255]
    v_mfma_f32_16x16x32_bf16 v[248:251], v[92:95], v[168:171], v[248:251]
    v_mfma_f32_16x16x32_bf16 v[244:247], v[88:91], v[168:171], v[244:247]
    v_mfma_f32_16x16x32_bf16 v[240:243], v[84:87], v[168:171], v[240:243]
    v_mfma_f32_16x16x32_bf16 v[236:239], v[80:83], v[168:171], v[236:239]
    buffer_load_dwordx4 v[168:171], v5, s[20:23], s11 offen offset:1024 sc1
    s_waitcnt vmcnt(7)
    v_mfma_f32_16x16x32_bf16 v[176:179], v[100:103], v[140:143], v[176:179]
    ds_read_b64 v[16:17], v13 offset:360
    v_mfma_f32_16x16x32_bf16 v[180:183], v[104:107], v[140:143], v[180:183]
    v_mfma_f32_16x16x32_bf16 v[184:187], v[108:111], v[140:143], v[184:187]
    v_mfma_f32_16x16x32_bf16 v[188:191], v[112:115], v[140:143], v[188:191]
    v_mfma_f32_16x16x32_bf16 v[192:195], v[116:119], v[140:143], v[192:195]
    buffer_load_dwordx4 v[140:143], v5, s[20:23], s8 offen offset:2048 sc1
    s_waitcnt vmcnt(7)
    v_mfma_f32_16x16x32_bf16 v[212:215], v[116:119], v[144:147], v[212:215]
    v_mfma_f32_16x16x32_bf16 v[208:211], v[112:115], v[144:147], v[208:211]
    v_mfma_f32_16x16x32_bf16 v[204:207], v[108:111], v[144:147], v[204:207]
    v_mfma_f32_16x16x32_bf16 v[200:203], v[104:107], v[144:147], v[200:203]
    v_mfma_f32_16x16x32_bf16 v[196:199], v[100:103], v[144:147], v[196:199]
    buffer_load_dwordx4 v[144:147], v5, s[20:23], s9 offen offset:2048 sc1
    s_waitcnt vmcnt(7)
    v_mfma_f32_16x16x32_bf16 v[216:219], v[100:103], v[148:151], v[216:219]
    v_mfma_f32_16x16x32_bf16 v[220:223], v[104:107], v[148:151], v[220:223]
    v_mfma_f32_16x16x32_bf16 v[224:227], v[108:111], v[148:151], v[224:227]
    v_mfma_f32_16x16x32_bf16 v[228:231], v[112:115], v[148:151], v[228:231]
    v_mfma_f32_16x16x32_bf16 v[232:235], v[116:119], v[148:151], v[232:235]
    buffer_load_dwordx4 v[148:151], v5, s[20:23], s10 offen offset:2048 sc1
    s_waitcnt vmcnt(7)
    v_mfma_f32_16x16x32_bf16 v[252:255], v[116:119], v[152:155], v[252:255]
    v_mfma_f32_16x16x32_bf16 v[248:251], v[112:115], v[152:155], v[248:251]
    v_mfma_f32_16x16x32_bf16 v[244:247], v[108:111], v[152:155], v[244:247]
    v_mfma_f32_16x16x32_bf16 v[240:243], v[104:107], v[152:155], v[240:243]
    v_mfma_f32_16x16x32_bf16 v[236:239], v[100:103], v[152:155], v[236:239]
    buffer_load_dwordx4 v[152:155], v5, s[20:23], s11 offen offset:2048 sc1
    s_waitcnt lgkmcnt(0)
    v_or_b32 v16, v16, v17
    v_cmp_ne_u32 vcc, 0, v16
    s_cbranch_vccnz LG2w
LG2wr:
    s_waitcnt vmcnt(7)
    v_mfma_f32_16x16x32_bf16 v[176:179], v[120:123], v[156:159], v[176:179]
    ds_read_b128 v[20:23], v3 offset:0
    v_mfma_f32_16x16x32_bf16 v[180:183], v[124:127], v[156:159], v[180:183]
    ds_read_b128 v[24:27], v3 offset:1024
    v_mfma_f32_16x16x32_bf16 v[184:187], v[128:131], v[156:159], v[184:187]
    ds_read_b128 v[28:31], v3 offset:2048
    v_mfma_f32_16x16x32_bf16 v[188:191], v[132:135], v[156:159], v[188:191]
    ds_read_b128 v[32:35], v3 offset:3072
    v_mfma_f32_16x16x32_bf16 v[192:195], v[136:139], v[156:159], v[192:195]
    buffer_load_dwordx4 v[156:159], v5, s[20:23], s8 offen offset:3072 sc1
    s_add_u32 s8, s8, 4096
    s_waitcnt vmcnt(7)
    v_mfma_f32_16x16x32_bf16 v[212:215], v[136:139], v[160:163], v[212:215]
    ds_read_b128 v[36:39], v3 offset:4096
    v_mfma_f32_16x16x32_bf16 v[208:211], v[132:135], v[160:163], v[208:211]
    ds_read_b128 v[40:43], v3 offset:5120
    v_mfma_f32_16x16x32_bf16 v[204:207], v[128:131], v[160:163], v[204:207]
    ds_read_b128 v[44:47], v3 offset:6144
    v_mfma_f32_16x16x32_bf16 v[200:203], v[124:127], v[160:163], v[200:203]
    ds_read_b128 v[48:51], v3 offset:7168
    v_mfma_f32_16x16x32_bf16 v[196:199], v[120:123], v[160:163], v[196:199]
    buffer_load_dwordx4 v[160:163], v5, s[20:23], s9 offen offset:3072 sc1
    s_add_u32 s9, s9, 4096
    s_waitcnt vmcnt(7)
    v_mfma_f32_16x16x32_bf16 v[216:219], v[120:123], v[164:167], v[216:219]
    ds_read_b128 v[52:55], v3 offset:8192
    v_mfma_f32_16x16x32_bf16 v[220:223], v[124:127], v[164:167], v[220:223]
    ds_read_b128 v[56:59], v3 offset:9216
    v_mfma_f32_16x16x32_bf16 v[224:227], v[128:131], v[164:167], v[224:227]
    v_mfma_f32_16x16x32_bf16 v[228:231], v[132:135], v[164:167], v[228:231]
    v_mfma_f32_16x16x32_bf16 v[232:235], v[136:139], v[164:167], v[232:235]
    buffer_load_dwordx4 v[164:167], v5, s[20:23], s10 offen offset:3072 sc1
    s_add_u32 s10, s10, 4096
    s_waitcnt vmcnt(7)
    v_mfma_f32_16x16x32_bf16 v[252:255], v[136:139], v[168:171], v[252:255]
    v_mfma_f32_16x16x32_bf16 v[248:251], v[132:135], v[168:171], v[248:251]
    v_mfma_f32_16x16x32_bf16 v[244:247], v[128:131], v[168:171], v[244:247]
    v_mfma_f32_16x16x32_bf16 v[240:243], v[124:127], v[168:171], v[240:243]
    v_mfma_f32_16x16x32_bf16 v[236:239], v[120:123], v[168:171], v[236:239]
    buffer_load_dwordx4 v[168:171], v5, s[20:23], s11 offen offset:3072 sc1
    s_add_u32 s11, s11, 4096
    s_waitcnt vmcnt(7) lgkmcnt(5)
    v_mfma_f32_16x16x32_bf16 v[176:179], v[20:23], v[140:143], v[176:179]
    ds_read_b128 v[60:63], v3 offset:10240
    v_mfma_f32_16x16x32_bf16 v[180:183], v[24:27], v[140:143], v[180:183]
    ds_read_b128 v[64:67], v3 offset:11264
    v_mfma_f32_16x16x32_bf16 v[184:187], v[28:31], v[140:143], v[184:187]
    ds_read_b128 v[68:71], v3 offset:12288
    v_mfma_f32_16x16x32_bf16 v[188:191], v[32:35], v[140:143], v[188:191]
    ds_read_b128 v[72:75], v3 offset:13312
    v_mfma_f32_16x16x32_bf16 v[192:195], v[36:39], v[140:143], v[192:195]
    buffer_load_dwordx4 v[140:143], v5, s[20:23], s8 offen offset:0 sc1
    s_waitcnt vmcnt(7)
    v_mfma_f32_16x16x32_bf16 v[212:215], v[36:39], v[144:147], v[212:215]
    ds_read_b128 v[76:79], v3 offset:14336
    v_mfma_f32_16x16x32_bf16 v[208:211], v[32:35], v[144:147], v[208:211]
    ds_read_b128 v[80:83], v3 offset:15360
    v_mfma_f32_16x16x32_bf16 v[204:207], v[28:31], v[144:147], v[204:207]
    ds_read_b128 v[84:87], v3 offset:16384
    v_mfma_f32_16x16x32_bf16 v[200:203], v[24:27], v[144:147], v[200:203]
    ds_read_b128 v[88:91], v3 offset:17408
    v_mfma_f32_16x16x32_bf16 v[196:199], v[20:23], v[144:147], v[196:199]
    buffer_load_dwordx4 v[144:147], v5, s[20:23], s9 offen offset:0 sc1
    s_waitcnt vmcnt(7)
    v_mfma_f32_16x16x32_bf16 v[216:219], v[20:23], v[148:151], v[216:219]
    ds_read_b128 v[92:95], v3 offset:18432
    v_mfma_f32_16x16x32_bf16 v[220:223], v[24:27], v[148:151], v[220:223]
    ds_read_b128 v[96:99], v3 offset:19456
    v_mfma_f32_16x16x32_bf16 v[224:227], v[28:31], v[148:151], v[224:227]
    v_mfma_f32_16x16x32_bf16 v[228:231], v[32:35], v[148:151], v[228:231]
    v_mfma_f32_16x16x32_bf16 v[232:235], v[36:39], v[148:151], v[232:235]
    buffer_load_dwordx4 v[148:151], v5, s[20:23], s10 offen offset:0 sc1
    s_waitcnt vmcnt(7)
    v_mfma_f32_16x16x32_bf16 v[252:255], v[36:39], v[152:155], v[252:255]
    v_mfma_f32_16x16x32_bf16 v[248:251], v[32:35], v[152:155], v[248:251]
    v_mfma_f32_16x16x32_bf16 v[244:247], v[28:31], v[152:155], v[244:247]
    v_mfma_f32_16x16x32_bf16 v[240:243], v[24:27], v[152:155], v[240:243]
    v_mfma_f32_16x16x32_bf16 v[236:239], v[20:23], v[152:155], v[236:239]
    buffer_load_dwordx4 v[152:155], v5, s[20:23], s11 offen offset:0 sc1
    s_waitcnt vmcnt(7) lgkmcnt(10)
    v_mfma_f32_16x16x32_bf16 v[176:179], v[40:43], v[156:159], v[176:179]
    ds_read_b128 v[100:103], v3 offset:20480
    v_mfma_f32_16x16x32_bf16 v[180:183], v[44:47], v[156:159], v[180:183]
    ds_read_b128 v[104:107], v3 offset:21504
    v_mfma_f32_16x16x32_bf16 v[184:187], v[48:51], v[156:159], v[184:187]
    ds_read_b128 v[108:111], v3 offset:22528
    v_mfma_f32_16x16x32_bf16 v[188:191], v[52:55], v[156:159], v[188:191]
    ds_read_b128 v[112:115], v3 offset:23552
    v_mfma_f32_16x16x32_bf16 v[192:195], v[56:59], v[156:159], v[192:195]
    buffer_load_dwordx4 v[156:159], v5, s[20:23], s8 offen offset:1024 sc1
    s_waitcnt vmcnt(7)
    v_mfma_f32_16x16x32_bf16 v[212:215], v[56:59], v[160:163], v[212:215]
    ds_read_b128 v[116:119], v3 offset:24576
    v_mfma_f32_16x16x32_bf16 v[208:211], v[52:55], v[160:163], v[208:211]
    ds_read_b128 v[20:23], v3 offset:25600
    v_mfma_f32_16x16x32_bf16 v[204:207], v[48:51], v[160:163], v[204:207]
    ds_read_b128 v[24:27], v3 offset:26624
    v_mfma_f32_16x16x32_bf16 v[200:203], v[44:47], v[160:163], v[200:203]
    ds_read_b128 v[28:31], v3 offset:27648
    v_mfma_f32_16x16x32_bf16 v[196:199], v[40:43], v[160:163], v[196:199]
    buffer_load_dwordx4 v[160:163], v5, s[20:23], s9 offen offset:1024 sc1
    s_waitcnt vmcnt(7)
    v_mfma_f32_16x16x32_bf16 v[216:219], v[40:43], v[164:167], v[216:219]
    ds_read_b128 v[32:35], v3 offset:28672
    v_mfma_f32_16x16x32_bf16 v[220:223], v[44:47], v[164:167], v[220:223]
    ds_read_b128 v[36:39], v3 offset:29696
    v_mfma_f32_16x16x32_bf16 v[224:227], v[48:51], v[164:167], v[224:227]
    v_mfma_f32_16x16x32_bf16 v[228:231], v[52:55], v[164:167], v[228:231]
    v_mfma_f32_16x16x32_bf16 v[232:235], v[56:59], v[164:167], v[232:235]
    buffer_load_dwordx4 v[164:167], v5, s[20:23], s10 offen offset:1024 sc1
    s_waitcnt vmcnt(7)
    v_mfma_f32_16x16x32_bf16 v[252:255], v[56:59], v[168:171], v[252:255]
    v_mfma_f32_16x16x32_bf16 v[248:251], v[52:55], v[168:171], v[248:251]
    v_mfma_f32_16x16x32_bf16 v[244:247], v[48:51], v[168:171], v[244:247]
    v_mfma_f32_16x16x32_bf16 v[240:243], v[44:47], v[168:171], v[240:243]
    v_mfma_f32_16x16x32_bf16 v[236:239], v[40:43], v[168:171], v[236:239]
    buffer_load_dwordx4 v[168:171], v5, s[20:23], s11 offen offset:1024 sc1
    s_waitcnt vmcnt(7) lgkmcnt(15)
    v_mfma_f32_16x16x32_bf16 v[176:179], v[60:63], v[140:143], v[176:179]
    v_mfma_f32_16x16x32_bf16 v[180:183], v[64:67], v[140:143], v[180:183]
    buffer_load_dwordx4 v[120:123], v5, s[20:23], s8 offen offset:3072 sc1
    v_mfma_f32_16x16x32_bf16 v[184:187], v[68:71], v[140:143], v[184:187]
    v_mfma_f32_16x16x32_bf16 v[188:191], v[72:75], v[140:143], v[188:191]
    v_mfma_f32_16x16x32_bf16 v[192:195], v[76:79], v[140:143], v[192:195]
    buffer_load_dwordx4 v[140:143], v5, s[20:23], s8 offen offset:2048 sc1
    s_waitcnt vmcnt(8)
    v_mfma_f32_16x16x32_bf16 v[212:215], v[76:79], v[144:147], v[212:215]
    v_mfma_f32_16x16x32_bf16 v[208:211], v[72:75], v[144:147], v[208:211]
    buffer_load_dwordx4 v[124:127], v5, s[20:23], s9 offen offset:3072 sc1
    v_mfma_f32_16x16x32_bf16 v[204:207], v[68:71], v[144:147], v[204:207]
    v_mfma_f32_16x16x32_bf16 v[200:203], v[64:67], v[144:147], v[200:203]
    v_mfma_f32_16x16x32_bf16 v[196:199], v[60:63], v[144:147], v[196:199]
    buffer_load_dwordx4 v[144:147], v5, s[20:23], s9 offen offset:2048 sc1
    s_waitcnt vmcnt(9)
    v_mfma_f32_16x16x32_bf16 v[216:219], v[60:63], v[148:151], v[216:219]
    v_mfma_f32_16x16x32_bf16 v[220:223], v[64:67], v[148:151], v[220:223]
    buffer_load_dwordx4 v[128:131], v5, s[20:23], s10 offen offset:3072 sc1
    v_mfma_f32_16x16x32_bf16 v[224:227], v[68:71], v[148:151], v[224:227]
    v_mfma_f32_16x16x32_bf16 v[228:231], v[72:75], v[148:151], v[228:231]
    v_mfma_f32_16x16x32_bf16 v[232:235], v[76:79], v[148:151], v[232:235]
    buffer_load_dwordx4 v[148:151], v5, s[20:23], s10 offen offset:2048 sc1
    s_waitcnt vmcnt(10)
    v_mfma_f32_16x16x32_bf16 v[252:255], v[76:79], v[152:155], v[252:255]
    v_mfma_f32_16x16x32_bf16 v[248:251], v[72:75], v[152:155], v[248:251]
    buffer_load_dwordx4 v[132:135], v5, s[20:23], s11 offen offset:3072 sc1
    v_mfma_f32_16x16x32_bf16 v[244:247], v[68:71], v[152:155], v[244:247]
    v_mfma_f32_16x16x32_bf16 v[240:243], v[64:67], v[152:155], v[240:243]
    v_mfma_f32_16x16x32_bf16 v[236:239], v[60:63], v[152:155], v[236:239]
    buffer_load_dwordx4 v[152:155], v5, s[20:23], s11 offen offset:2048 sc1
    s_waitcnt vmcnt(11) lgkmcnt(0)
    v_mfma_f32_16x16x32_bf16 v[176:179], v[80:83], v[156:159], v[176:179]
    v_mfma_f32_16x16x32_bf16 v[180:183], v[84:87], v[156:159], v[180:183]
    v_mfma_f32_16x16x32_bf16 v[184:187], v[88:91], v[156:159], v[184:187]
    v_mfma_f32_16x16x32_bf16 v[188:191], v[92:95], v[156:159], v[188:191]
    v_mfma_f32_16x16x32_bf16 v[192:195], v[96:99], v[156:159], v[192:195]
    s_waitcnt vmcnt(6)
    v_mfma_f32_16x16x32_bf16 v[176:179], v[100:103], v[140:143], v[176:179]
    v_mfma_f32_16x16x32_bf16 v[180:183], v[104:107], v[140:143], v[180:183]
    v_mfma_f32_16x16x32_bf16 v[184:187], v[108:111], v[140:143], v[184:187]
    v_mfma_f32_16x16x32_bf16 v[188:191], v[112:115], v[140:143], v[188:191]
    v_mfma_f32_16x16x32_bf16 v[192:195], v[116:119], v[140:143], v[192:195]
    s_waitcnt vmcnt(7)
    v_mfma_f32_16x16x32_bf16 v[176:179], v[20:23], v[120:123], v[176:179]
    v_mfma_f32_16x16x32_bf16 v[180:183], v[24:27], v[120:123], v[180:183]
    v_mfma_f32_16x16x32_bf16 v[184:187], v[28:31], v[120:123], v[184:187]
    v_mfma_f32_16x16x32_bf16 v[188:191], v[32:35], v[120:123], v[188:191]
    v_mfma_f32_16x16x32_bf16 v[192:195], v[36:39], v[120:123], v[192:195]
    s_waitcnt vmcnt(10)
    v_mfma_f32_16x16x32_bf16 v[196:199], v[80:83], v[160:163], v[196:199]
    v_mfma_f32_16x16x32_bf16 v[200:203], v[84:87], v[160:163], v[200:203]
    v_mfma_f32_16x16x32_bf16 v[204:207], v[88:91], v[160:163], v[204:207]
    v_mfma_f32_16x16x32_bf16 v[208:211], v[92:95], v[160:163], v[208:211]
    ds_write_b128 v3, v[176:179] offset:0
    v_mfma_f32_16x16x32_bf16 v[212:215], v[96:99], v[160:163], v[212:215]
    s_waitcnt vmcnt(4)
    v_mfma_f32_16x16x32_bf16 v[196:199], v[100:103], v[144:147], v[196:199]
    ds_write_b128 v3, v[180:183] offset:1024
    v_mfma_f32_16x16x32_bf16 v[200:203], v[104:107], v[144:147], v[200:203]
    v_mfma_f32_16x16x32_bf16 v[204:207], v[108:111], v[144:147], v[204:207]
    ds_write_b128 v3, v[184:187] offset:2048
    v_mfma_f32_16x16x32_bf16 v[208:211], v[112:115], v[144:147], v[208:211]
    v_mfma_f32_16x16x32_bf16 v[212:215], v[116:119], v[144:147], v[212:215]
    ds_write_b128 v3, v[188:191] offset:3072
    s_waitcnt vmcnt(5)
    v_mfma_f32_16x16x32_bf16 v[196:199], v[20:23], v[124:127], v[196:199]
    v_mfma_f32_16x16x32_bf16 v[200:203], v[24:27], v[124:127], v[200:203]
    ds_write_b128 v3, v[192:195] offset:4096
    v_mfma_f32_16x16x32_bf16 v[204:207], v[28:31], v[124:127], v[204:207]
    v_mfma_f32_16x16x32_bf16 v[208:211], v[32:35], v[124:127], v[208:211]
    v_mfma_f32_16x16x32_bf16 v[212:215], v[36:39], v[124:127], v[212:215]
    s_waitcnt vmcnt(9)
    v_mfma_f32_16x16x32_bf16 v[216:219], v[80:83], v[164:167], v[216:219]
    v_mfma_f32_16x16x32_bf16 v[220:223], v[84:87], v[164:167], v[220:223]
    v_mfma_f32_16x16x32_bf16 v[224:227], v[88:91], v[164:167], v[224:227]
    v_mfma_f32_16x16x32_bf16 v[228:231], v[92:95], v[164:167], v[228:231]
    ds_write_b128 v3, v[196:199] offset:5120
    v_mfma_f32_16x16x32_bf16 v[232:235], v[96:99], v[164:167], v[232:235]
    s_waitcnt vmcnt(2)
    v_mfma_f32_16x16x32_bf16 v[216:219], v[100:103], v[148:151], v[216:219]
    ds_write_b128 v3, v[200:203] offset:6144
    v_mfma_f32_16x16x32_bf16 v[220:223], v[104:107], v[148:151], v[220:223]
    v_mfma_f32_16x16x32_bf16 v[224:227], v[108:111], v[148:151], v[224:227]
    ds_write_b128 v3, v[204:207] offset:7168
    v_mfma_f32_16x16x32_bf16 v[228:231], v[112:115], v[148:151], v[228:231]
    v_mfma_f32_16x16x32_bf16 v[232:235], v[116:119], v[148:151], v[232:235]
    ds_write_b128 v3, v[208:211] offset:8192
    s_waitcnt vmcnt(3)
    v_mfma_f32_16x16x32_bf16 v[216:219], v[20:23], v[128:131], v[216:219]
    v_mfma_f32_16x16x32_bf16 v[220:223], v[24:27], v[128:131], v[220:223]
    ds_write_b128 v3, v[212:215] offset:9216
    v_mfma_f32_16x16x32_bf16 v[224:227], v[28:31], v[128:131], v[224:227]
    v_mfma_f32_16x16x32_bf16 v[228:231], v[32:35], v[128:131], v[228:231]
    v_mfma_f32_16x16x32_bf16 v[232:235], v[36:39], v[128:131], v[232:235]
    s_waitcnt vmcnt(8)
    v_mfma_f32_16x16x32_bf16 v[236:239], v[80:83], v[168:171], v[236:239]
    v_mfma_f32_16x16x32_bf16 v[240:243], v[84:87], v[168:171], v[240:243]
    v_mfma_f32_16x16x32_bf16 v[244:247], v[88:91], v[168:171], v[244:247]
    v_mfma_f32_16x16x32_bf16 v[248:251], v[92:95], v[168:171], v[248:251]
    ds_write_b128 v3, v[216:219] offset:10240
    v_mfma_f32_16x16x32_bf16 v[252:255], v[96:99], v[168:171], v[252:255]
    s_waitcnt vmcnt(0)
    v_mfma_f32_16x16x32_bf16 v[236:239], v[100:103], v[152:155], v[236:239]
    ds_write_b128 v3, v[220:223] offset:11264
    v_mfma_f32_16x16x32_bf16 v[240:243], v[104:107], v[152:155], v[240:243]
    v_mfma_f32_16x16x32_bf16 v[244:247], v[108:111], v[152:155], v[244:247]
    ds_write_b128 v3, v[224:227] offset:12288
    v_mfma_f32_16x16x32_bf16 v[248:251], v[112:115], v[152:155], v[248:251]
    v_mfma_f32_16x16x32_bf16 v[252:255], v[116:119], v[152:155], v[252:255]
    ds_write_b128 v3, v[228:231] offset:13312
    s_waitcnt vmcnt(1)
    v_mfma_f32_16x16x32_bf16 v[236:239], v[20:23], v[132:135], v[236:239]
    v_mfma_f32_16x16x32_bf16 v[240:243], v[24:27], v[132:135], v[240:243]
    ds_write_b128 v3, v[232:235] offset:14336
    v_mfma_f32_16x16x32_bf16 v[244:247], v[28:31], v[132:135], v[244:247]
    v_mfma_f32_16x16x32_bf16 v[248:251], v[32:35], v[132:135], v[248:251]
    v_mfma_f32_16x16x32_bf16 v[252:255], v[36:39], v[132:135], v[252:255]
    s_waitcnt lgkmcnt(0)
    s_barrier
    ds_read2st64_b32 v[80:81], v6 offset0:0 offset1:1
    ds_read_b128 v[100:103], v8 offset:0
    ds_read_b128 v[104:107], v9 offset:5120
    ds_read_b128 v[108:111], v10 offset:10240
    ds_read_b64_tr_b16 v[20:21], v11 offset:0
    ds_read_b128 v[112:115], v8 offset:1024
    ds_read_b128 v[116:119], v9 offset:6144
    ds_read_b128 v[120:123], v10 offset:11264
    ds_read_b64_tr_b16 v[22:23], v11 offset:512
    ds_read_b128 v[124:127], v8 offset:2048
    ds_read_b128 v[128:131], v9 offset:7168
    ds_read_b128 v[132:135], v10 offset:12288
    ds_read_b64_tr_b16 v[24:25], v11 offset:4096
    ds_read_b128 v[136:139], v8 offset:3072
    ds_read_b128 v[140:143], v9 offset:8192
    ds_read_b128 v[144:147], v10 offset:13312
    ds_read_b64_tr_b16 v[26:27], v11 offset:4608
    ds_read_b128 v[148:151], v8 offset:4096
    ds_read_b128 v[152:155], v9 offset:9216
    ds_read_b128 v[156:159], v10 offset:14336
    ds_read_b64_tr_b16 v[28:29], v4 offset:8192
    s_waitcnt lgkmcnt(15)
    v_add_f32 v80, v80, v81
    v_cvt_pk_bf16_f32 v80, v80, v80
    v_lshlrev_b32 v80, 16, v80
    v_mul_f32 v80, 0xbfb8aa3b, v80
    v_exp_f32 v80, v80
    s_nop 0
    v_add_f32 v80, 1.0, v80
    v_rcp_f32 v80, v80
    s_nop 0
    v_cvt_pk_bf16_f32 v80, v80, v80
    v_lshlrev_b32 v80, 16, v80
    v_sub_f32 v82, 1.0, v80
    v_cvt_pk_bf16_f32 v82, v82, v82
    v_lshlrev_b32 v82, 16, v82
    s_waitcnt lgkmcnt(15)
    v_pk_add_f32 v[236:237], v[236:237], v[100:101]
    v_pk_add_f32 v[104:105], v[104:105], v[108:109]
    v_lshlrev_b32_e64 v44, 16, v20
    v_and_b32 v45, 0xffff0000, v20
    v_pk_add_f32 v[238:239], v[238:239], v[102:103]
    v_pk_add_f32 v[106:107], v[106:107], v[110:111]
    v_lshlrev_b32_e64 v46, 16, v21
    v_and_b32 v47, 0xffff0000, v21
    v_pk_add_f32 v[236:237], v[236:237], v[104:105]
    v_pk_mul_f32 v[44:45], v[44:45], v[80:81] op_sel_hi:[1,0]
    v_pk_add_f32 v[238:239], v[238:239], v[106:107]
    v_pk_mul_f32 v[46:47], v[46:47], v[80:81] op_sel_hi:[1,0]
    v_pk_fma_f32 v[236:237], v[236:237], v[82:83], v[44:45] op_sel_hi:[1,0,1]
    v_pk_fma_f32 v[238:239], v[238:239], v[82:83], v[46:47] op_sel_hi:[1,0,1]
    v_cvt_pk_bf16_f32 v32, v236, v237
    v_cvt_pk_bf16_f32 v33, v238, v239
    s_waitcnt lgkmcnt(12)
    v_pk_add_f32 v[240:241], v[240:241], v[112:113]
    v_pk_add_f32 v[116:117], v[116:117], v[120:121]
    v_lshlrev_b32 v44, 16, v22
    v_and_b32 v45, 0xffff0000, v22
    v_pk_add_f32 v[242:243], v[242:243], v[114:115]
    v_pk_add_f32 v[118:119], v[118:119], v[122:123]
    v_lshlrev_b32_e64 v46, 16, v23
    v_and_b32 v47, 0xffff0000, v23
    v_pk_add_f32 v[240:241], v[240:241], v[116:117]
    v_pk_mul_f32 v[44:45], v[44:45], v[80:81] op_sel_hi:[1,0]
    v_pk_add_f32 v[242:243], v[242:243], v[118:119]
    v_pk_mul_f32 v[46:47], v[46:47], v[80:81] op_sel_hi:[1,0]
    v_pk_fma_f32 v[240:241], v[240:241], v[82:83], v[44:45] op_sel_hi:[1,0,1]
    v_pk_fma_f32 v[242:243], v[242:243], v[82:83], v[46:47] op_sel_hi:[1,0,1]
    v_cvt_pk_bf16_f32 v34, v240, v241
    v_cvt_pk_bf16_f32 v35, v242, v243
    buffer_store_dwordx4 v[32:35], v2, s[12:15], 0 offen
    s_waitcnt lgkmcnt(8)
    v_pk_add_f32 v[244:245], v[244:245], v[124:125]
    v_pk_add_f32 v[128:129], v[128:129], v[132:133]
    v_lshlrev_b32 v44, 16, v24
    v_and_b32 v45, 0xffff0000, v24
    v_pk_add_f32 v[246:247], v[246:247], v[126:127]
    v_pk_add_f32 v[130:131], v[130:131], v[134:135]
    v_lshlrev_b32_e64 v46, 16, v25
    v_and_b32 v47, 0xffff0000, v25
    v_pk_add_f32 v[244:245], v[244:245], v[128:129]
    v_pk_mul_f32 v[44:45], v[44:45], v[80:81] op_sel_hi:[1,0]
    v_pk_add_f32 v[246:247], v[246:247], v[130:131]
    v_pk_mul_f32 v[46:47], v[46:47], v[80:81] op_sel_hi:[1,0]
    v_pk_fma_f32 v[244:245], v[244:245], v[82:83], v[44:45] op_sel_hi:[1,0,1]
    v_pk_fma_f32 v[246:247], v[246:247], v[82:83], v[46:47] op_sel_hi:[1,0,1]
    v_cvt_pk_bf16_f32 v36, v244, v245
    v_cvt_pk_bf16_f32 v37, v246, v247
    s_waitcnt lgkmcnt(4)
    v_pk_add_f32 v[248:249], v[248:249], v[136:137]
    v_pk_add_f32 v[140:141], v[140:141], v[144:145]
    v_lshlrev_b32 v44, 16, v26
    v_and_b32 v45, 0xffff0000, v26
    v_pk_add_f32 v[250:251], v[250:251], v[138:139]
    v_pk_add_f32 v[142:143], v[142:143], v[146:147]
    v_lshlrev_b32_e64 v46, 16, v27
    v_and_b32 v47, 0xffff0000, v27
    v_pk_add_f32 v[248:249], v[248:249], v[140:141]
    v_pk_mul_f32 v[44:45], v[44:45], v[80:81] op_sel_hi:[1,0]
    v_pk_add_f32 v[250:251], v[250:251], v[142:143]
    v_pk_mul_f32 v[46:47], v[46:47], v[80:81] op_sel_hi:[1,0]
    v_pk_fma_f32 v[248:249], v[248:249], v[82:83], v[44:45] op_sel_hi:[1,0,1]
    v_pk_fma_f32 v[250:251], v[250:251], v[82:83], v[46:47] op_sel_hi:[1,0,1]
    v_cvt_pk_bf16_f32 v38, v248, v249
    v_cvt_pk_bf16_f32 v39, v250, v251
    buffer_store_dwordx4 v[36:39], v2, s[12:15], 0 offen offset:64
    s_waitcnt lgkmcnt(0)
    v_pk_add_f32 v[252:253], v[252:253], v[148:149]
    v_pk_add_f32 v[152:153], v[152:153], v[156:157]
    v_lshlrev_b32 v44, 16, v28
    v_and_b32 v45, 0xffff0000, v28
    v_pk_add_f32 v[254:255], v[254:255], v[150:151]
    v_pk_add_f32 v[154:155], v[154:155], v[158:159]
    v_lshlrev_b32_e64 v46, 16, v29
    v_and_b32 v47, 0xffff0000, v29
    v_pk_add_f32 v[252:253], v[252:253], v[152:153]
    v_pk_mul_f32 v[44:45], v[44:45], v[80:81] op_sel_hi:[1,0]
    v_pk_add_f32 v[254:255], v[254:255], v[154:155]
    v_pk_mul_f32 v[46:47], v[46:47], v[80:81] op_sel_hi:[1,0]
    v_pk_fma_f32 v[252:253], v[252:253], v[82:83], v[44:45] op_sel_hi:[1,0,1]
    v_pk_fma_f32 v[254:255], v[254:255], v[82:83], v[46:47] op_sel_hi:[1,0,1]
    v_cvt_pk_bf16_f32 v40, v252, v253
    v_cvt_pk_bf16_f32 v41, v254, v255
    buffer_store_dwordx2 v[40:41], v12, s[12:15], 0 offen offset:128
    s_endpgm
LSC:
    s_cmp_lg_u32 s3, 4
    s_cbranch_scc1 LS
    s_lshl_b32 s4, s28, 7
    v_add_u32_e64 v3, s4, v0
    v_mul_u32_u24 v3, 1280, v3
    v_mul_u32_u24 v5, 10923, v0
    v_lshrrev_b32 v5, 16, v5
    v_mul_u32_u24 v6, 6, v5
    v_sub_u32 v6, v0, v6
    s_lshl_b32 s4, s7, 3
    v_min_u32 v5, 7, v5
    v_add_u32 v5, s4, v5
    v_mul_u32_u24 v5, 3072, v5
    v_lshl_add_u32 v5, v6, 7, v5
    s_and_b32 s4, s66, 3
    s_mul_i32 s4, s4, 768
    v_add_u32 v5, s4, v5
    v_add_u32 v4, 81920, v3
    v_mov_b32 v10, 163200
    s_mov_b32 s6, 1280
    s_mov_b32 s7, 1966080
    s_waitcnt lgkmcnt(0)
    s_mov_b64 s[8:9], s[36:37]
    s_mov_b32 s10, 0x280000
    s_mov_b32 s11, 0x20000
    s_mov_b64 s[12:13], s[52:53]
    s_mov_b32 s14, 0x1e0000
    s_mov_b32 s15, 0x20000
    s_mov_b64 s[16:17], s[54:55]
    s_mov_b32 s18, 0x1e0000
    s_mov_b32 s19, 0x20000
    s_mov_b64 s[20:21], s[64:65]
    s_mov_b32 s22, 0x1080000
    s_mov_b32 s23, 0x20000
    s_mov_b64 s[24:25], s[62:63]
    s_mov_b32 s26, 0x100
    s_mov_b32 s27, 0x20000
    v_mul_u32_u24 v26, 2731, v0
    v_lshrrev_b32 v26, 16, v26
    v_mul_u32_u24 v27, 24, v26
    v_sub_u32 v27, v0, v27
    v_min_u32 v26, 1, v26
    v_mul_u32_u24 v26, 196608, v26
    v_lshl_add_u32 v26, v27, 7, v26
    s_sub_u32 s4, s2, 192
    s_add_u32 s4, s4, 64
    s_mul_i32 s4, s4, 3072
    s_mov_b32 s33, s4
    s_barrier
    s_mov_b32 exec_hi, 0xffff
    s_mov_b32 exec_hi, -1
    s_lshl_b32 s35, s66, 2
    s_bfe_u32 s4, s67, 0x20001
    s_add_u32 s35, s35, s4
    s_and_b32 s32, s67, 1
    v_lshrrev_b32 v16, 3, v0
    v_and_b32_e64 v18, 7, v0
    v_mul_u32_u24 v17, 1280, v16
    v_lshl_add_u32 v17, v18, 4, v17
    s_mul_i32 s4, s35, 81920
    s_mul_i32 s5, s32, 640
    s_add_u32 s4, s4, s5
    s_mov_b32 m0, 32768
    v_xor_b32 v64, 0, v17
    v_add_u32 v64, 0, v64
    v_xor_b32 v65, 16, v17
    v_add_u32 v65, 9216, v65
    v_xor_b32 v66, 32, v17
    v_add_u32 v66, 18432, v66
    v_xor_b32 v67, 48, v17
    v_add_u32 v67, 27648, v67
    v_xor_b32_e64 v68, 64, v17
    v_add_u32 v68, 40960, v68
    v_xor_b32 v69, 80, v17
    v_add_u32 v69, 50176, v69
    v_xor_b32 v70, 96, v17
    v_add_u32 v70, 59392, v70
    v_xor_b32 v71, 112, v17
    v_add_u32 v71, 68608, v71
    buffer_load_dwordx4 v64, s[8:11], s4 offen offset:0 lds
    buffer_load_dwordx4 v65, s[8:11], s4 offen offset:1024 lds
    buffer_load_dwordx4 v66, s[8:11], s4 offen offset:2048 lds
    buffer_load_dwordx4 v67, s[8:11], s4 offen offset:3072 lds
    s_add_u32 m0, m0, 4096
    s_nop 0
    buffer_load_dwordx4 v68, s[8:11], s4 offen offset:0 lds
    buffer_load_dwordx4 v69, s[8:11], s4 offen offset:1024 lds
    buffer_load_dwordx4 v70, s[8:11], s4 offen offset:2048 lds
    buffer_load_dwordx4 v71, s[8:11], s4 offen offset:3072 lds
    s_add_u32 m0, m0, 4096
    s_add_u32 s4, s4, 128
    buffer_load_dwordx4 v64, s[8:11], s4 offen offset:0 lds
    buffer_load_dwordx4 v65, s[8:11], s4 offen offset:1024 lds
    buffer_load_dwordx4 v66, s[8:11], s4 offen offset:2048 lds
    buffer_load_dwordx4 v67, s[8:11], s4 offen offset:3072 lds
    s_add_u32 m0, m0, 4096
    s_nop 0
    buffer_load_dwordx4 v68, s[8:11], s4 offen offset:0 lds
    buffer_load_dwordx4 v69, s[8:11], s4 offen offset:1024 lds
    buffer_load_dwordx4 v70, s[8:11], s4 offen offset:2048 lds
    buffer_load_dwordx4 v71, s[8:11], s4 offen offset:3072 lds
    s_add_u32 m0, m0, 4096
    s_add_u32 s4, s4, 128
    buffer_load_dwordx4 v64, s[8:11], s4 offen offset:0 lds
    buffer_load_dwordx4 v65, s[8:11], s4 offen offset:1024 lds
    buffer_load_dwordx4 v66, s[8:11], s4 offen offset:2048 lds
    buffer_load_dwordx4 v67, s[8:11], s4 offen offset:3072 lds
    s_add_u32 m0, m0, 4096
    s_nop 0
    buffer_load_dwordx4 v68, s[8:11], s4 offen offset:0 lds
    buffer_load_dwordx4 v69, s[8:11], s4 offen offset:1024 lds
    buffer_load_dwordx4 v70, s[8:11], s4 offen offset:2048 lds
    buffer_load_dwordx4 v71, s[8:11], s4 offen offset:3072 lds
    s_add_u32 m0, m0, 4096
    s_add_u32 s4, s4, 128
    buffer_load_dwordx4 v64, s[8:11], s4 offen offset:0 lds
    buffer_load_dwordx4 v65, s[8:11], s4 offen offset:1024 lds
    buffer_load_dwordx4 v66, s[8:11], s4 offen offset:2048 lds
    buffer_load_dwordx4 v67, s[8:11], s4 offen offset:3072 lds
    s_add_u32 m0, m0, 4096
    s_nop 0
    buffer_load_dwordx4 v68, s[8:11], s4 offen offset:0 lds
    buffer_load_dwordx4 v69, s[8:11], s4 offen offset:1024 lds
    buffer_load_dwordx4 v70, s[8:11], s4 offen offset:2048 lds
    buffer_load_dwordx4 v71, s[8:11], s4 offen offset:3072 lds
    s_add_u32 m0, m0, 4096
    s_add_u32 s4, s4, 128
    buffer_load_dwordx4 v64, s[8:11], s4 offen offset:0 lds
    buffer_load_dwordx4 v65, s[8:11], s4 offen offset:1024 lds
    buffer_load_dwordx4 v66, s[8:11], s4 offen offset:2048 lds
    buffer_load_dwordx4 v67, s[8:11], s4 offen offset:3072 lds
    s_add_u32 m0, m0, 4096
    s_nop 0
    buffer_load_dwordx4 v68, s[8:11], s4 offen offset:0 lds
    buffer_load_dwordx4 v69, s[8:11], s4 offen offset:1024 lds
    buffer_load_dwordx4 v70, s[8:11], s4 offen offset:2048 lds
    buffer_load_dwordx4 v71, s[8:11], s4 offen offset:3072 lds
    s_add_u32 m0, m0, 4096
    s_add_u32 s4, s4, 128
    s_mov_b64 s[28:29], s[58:59]
    s_mov_b32 s30, 0x500
    s_mov_b32 s31, 0x20000
    v_lshlrev_b32_e64 v17, 4, v16
    buffer_load_dwordx4 v[32:35], v17, s[28:31], s5 offen offset:0
    buffer_load_dwordx4 v[36:39], v17, s[28:31], s5 offen offset:128
    buffer_load_dwordx4 v[40:43], v17, s[28:31], s5 offen offset:256
    buffer_load_dwordx4 v[44:47], v17, s[28:31], s5 offen offset:384
    buffer_load_dwordx4 v[48:51], v17, s[28:31], s5 offen offset:512
    s_mov_b32 s4, 384
    s_mov_b32 s5, 589824
    buffer_load_dword v28, v5, s[12:15], s5 offen
    buffer_load_dword v28, v5, s[16:19], s5 offen
    s_mov_b32 s4, 512
    s_mov_b32 s5, 786432
    buffer_load_dword v28, v5, s[12:15], s5 offen
    buffer_load_dword v28, v5, s[16:19], s5 offen
    s_mov_b32 s4, 640
    s_mov_b32 s5, 983040
    buffer_load_dword v28, v5, s[12:15], s5 offen
    buffer_load_dword v28, v5, s[16:19], s5 offen
    s_mov_b32 s4, 768
    s_mov_b32 s5, 1179648
    buffer_load_dword v28, v5, s[12:15], s5 offen
    buffer_load_dword v28, v5, s[16:19], s5 offen
    s_mov_b32 s4, 896
    s_mov_b32 s5, 1376256
    buffer_load_dword v28, v5, s[12:15], s5 offen
    buffer_load_dword v28, v5, s[16:19], s5 offen
    s_mov_b32 s4, 1024
    s_mov_b32 s5, 1572864
    buffer_load_dword v28, v5, s[12:15], s5 offen
    buffer_load_dword v28, v5, s[16:19], s5 offen
    s_mov_b32 s4, 1152
    s_mov_b32 s5, 1769472
    buffer_load_dword v28, v5, s[12:15], s5 offen
    buffer_load_dword v28, v5, s[16:19], s5 offen
    s_mov_b32 exec_hi, 0xffff
    s_mov_b32 exec_hi, -1
    v_mov_b32 v12, 0
    buffer_load_dword v13, v12, s[24:27], 0 offen sc1
    s_setprio 3
    v_xor_b32 v19, v16, v18
    v_lshlrev_b32_e64 v19, 4, v19
    v_lshl_add_u32 v19, v18, 10, v19
    v_add_u32 v19, 32768, v19
    v_xor_b32 v20, 7, v18
    v_lshlrev_b32 v20, 4, v20
    v_lshl_add_u32 v20, v16, 15, v20
    s_mul_i32 s34, s32, 1310720
    s_lshl_b32 s4, s35, 7
    s_sub_u32 s34, s34, s4
    s_add_u32 s34, s34, 135040
    s_mov_b32 s28, 0x05040100
    s_mov_b32 s29, 0x07060302
    v_mov_b32 v52, 0
    v_mov_b32 v53, 0
    v_mov_b32 v54, 0
    v_mov_b32 v55, 0
    v_mov_b32 v56, 0
    v_mov_b32 v57, 0
    v_mov_b32 v58, 0
    v_mov_b32 v59, 0
    s_waitcnt vmcnt(15)
    s_nop 0
    ds_read_b128 v[64:67], v19 offset:0
    ds_read_b128 v[68:71], v19 offset:128
    ds_read_b128 v[72:75], v19 offset:256
    ds_read_b128 v[76:79], v19 offset:384
    ds_read_b128 v[80:83], v19 offset:512
    ds_read_b128 v[84:87], v19 offset:640
    ds_read_b128 v[88:91], v19 offset:768
    ds_read_b128 v[92:95], v19 offset:896
    ds_read_b128 v[96:99], v19 offset:8192
    ds_read_b128 v[100:103], v19 offset:8320
    ds_read_b128 v[104:107], v19 offset:8448
    ds_read_b128 v[108:111], v19 offset:8576
    ds_read_b128 v[112:115], v19 offset:8704
    ds_read_b128 v[116:119], v19 offset:8832
    ds_read_b128 v[120:123], v19 offset:8960
    ds_read_b128 v[124:127], v19 offset:9088
    s_waitcnt lgkmcnt(8)
    s_nop 0
    v_perm_b32 v128, v88, v92, s28
    v_perm_b32 v129, v80, v84, s28
    v_perm_b32 v130, v72, v76, s28
    v_perm_b32 v131, v64, v68, s28
    buffer_store_dwordx4 v[128:131], v20, s[20:23], s34 offen sc1
    s_add_u32 s34, s34, 4096
    v_perm_b32 v132, v88, v92, s29
    v_perm_b32 v133, v80, v84, s29
    v_perm_b32 v134, v72, v76, s29
    v_perm_b32 v135, v64, v68, s29
    buffer_store_dwordx4 v[132:135], v20, s[20:23], s34 offen sc1
    s_add_u32 s34, s34, 4096
    v_perm_b32 v136, v89, v93, s28
    v_perm_b32 v137, v81, v85, s28
    v_perm_b32 v138, v73, v77, s28
    v_perm_b32 v139, v65, v69, s28
    buffer_store_dwordx4 v[136:139], v20, s[20:23], s34 offen sc1
    s_add_u32 s34, s34, 4096
    v_perm_b32 v140, v89, v93, s29
    v_perm_b32 v141, v81, v85, s29
    v_perm_b32 v142, v73, v77, s29
    v_perm_b32 v143, v65, v69, s29
    buffer_store_dwordx4 v[140:143], v20, s[20:23], s34 offen sc1
    s_add_u32 s34, s34, 4096
    v_perm_b32 v144, v90, v94, s28
    v_perm_b32 v145, v82, v86, s28
    v_perm_b32 v146, v74, v78, s28
    v_perm_b32 v147, v66, v70, s28
    buffer_store_dwordx4 v[144:147], v20, s[20:23], s34 offen sc1
    s_add_u32 s34, s34, 4096
    v_perm_b32 v148, v90, v94, s29
    v_perm_b32 v149, v82, v86, s29
    v_perm_b32 v150, v74, v78, s29
    v_perm_b32 v151, v66, v70, s29
    buffer_store_dwordx4 v[148:151], v20, s[20:23], s34 offen sc1
    s_add_u32 s34, s34, 4096
    v_perm_b32 v152, v91, v95, s28
    v_perm_b32 v153, v83, v87, s28
    v_perm_b32 v154, v75, v79, s28
    v_perm_b32 v155, v67, v71, s28
    buffer_store_dwordx4 v[152:155], v20, s[20:23], s34 offen sc1
    s_add_u32 s34, s34, 4096
    v_perm_b32 v156, v91, v95, s29
    v_perm_b32 v157, v83, v87, s29
    v_perm_b32 v158, v75, v79, s29
    v_perm_b32 v159, v67, v71, s29
    buffer_store_dwordx4 v[156:159], v20, s[20:23], s34 offen sc1
    s_add_u32 s34, s34, 233472
    v_dot2c_f32_bf16 v52, v64, v32
    v_dot2c_f32_bf16 v53, v68, v32
    v_dot2c_f32_bf16 v54, v72, v32
    v_dot2c_f32_bf16 v55, v76, v32
    v_dot2c_f32_bf16 v56, v80, v32
    v_dot2c_f32_bf16 v57, v84, v32
    v_dot2c_f32_bf16 v58, v88, v32
    v_dot2c_f32_bf16 v59, v92, v32
    v_dot2c_f32_bf16 v52, v65, v33
    v_dot2c_f32_bf16 v53, v69, v33
    v_dot2c_f32_bf16 v54, v73, v33
    v_dot2c_f32_bf16 v55, v77, v33
    v_dot2c_f32_bf16 v56, v81, v33
    v_dot2c_f32_bf16 v57, v85, v33
    v_dot2c_f32_bf16 v58, v89, v33
    v_dot2c_f32_bf16 v59, v93, v33
    v_dot2c_f32_bf16 v52, v66, v34
    v_dot2c_f32_bf16 v53, v70, v34
    v_dot2c_f32_bf16 v54, v74, v34
    v_dot2c_f32_bf16 v55, v78, v34
    v_dot2c_f32_bf16 v56, v82, v34
    v_dot2c_f32_bf16 v57, v86, v34
    v_dot2c_f32_bf16 v58, v90, v34
    v_dot2c_f32_bf16 v59, v94, v34
    v_dot2c_f32_bf16 v52, v67, v35
    v_dot2c_f32_bf16 v53, v71, v35
    v_dot2c_f32_bf16 v54, v75, v35
    v_dot2c_f32_bf16 v55, v79, v35
    v_dot2c_f32_bf16 v56, v83, v35
    v_dot2c_f32_bf16 v57, v87, v35
    v_dot2c_f32_bf16 v58, v91, v35
    v_dot2c_f32_bf16 v59, v95, v35
    ds_read_b128 v[64:67], v19 offset:16384
    ds_read_b128 v[68:71], v19 offset:16512
    ds_read_b128 v[72:75], v19 offset:16640
    ds_read_b128 v[76:79], v19 offset:16768
    ds_read_b128 v[80:83], v19 offset:16896
    ds_read_b128 v[84:87], v19 offset:17024
    ds_read_b128 v[88:91], v19 offset:17152
    ds_read_b128 v[92:95], v19 offset:17280
    s_waitcnt lgkmcnt(8)
    s_nop 0
    v_perm_b32 v128, v120, v124, s28
    v_perm_b32 v129, v112, v116, s28
    v_perm_b32 v130, v104, v108, s28
    v_perm_b32 v131, v96, v100, s28
    buffer_store_dwordx4 v[128:131], v20, s[20:23], s34 offen sc1
    s_add_u32 s34, s34, 4096
    v_perm_b32 v132, v120, v124, s29
    v_perm_b32 v133, v112, v116, s29
    v_perm_b32 v134, v104, v108, s29
    v_perm_b32 v135, v96, v100, s29
    buffer_store_dwordx4 v[132:135], v20, s[20:23], s34 offen sc1
    s_add_u32 s34, s34, 4096
    v_perm_b32 v136, v121, v125, s28
    v_perm_b32 v137, v113, v117, s28
    v_perm_b32 v138, v105, v109, s28
    v_perm_b32 v139, v97, v101, s28
    buffer_store_dwordx4 v[136:139], v20, s[20:23], s34 offen sc1
    s_add_u32 s34, s34, 4096
    v_perm_b32 v140, v121, v125, s29
    v_perm_b32 v141, v113, v117, s29
    v_perm_b32 v142, v105, v109, s29
    v_perm_b32 v143, v97, v101, s29
    buffer_store_dwordx4 v[140:143], v20, s[20:23], s34 offen sc1
    s_add_u32 s34, s34, 4096
    v_perm_b32 v144, v122, v126, s28
    v_perm_b32 v145, v114, v118, s28
    v_perm_b32 v146, v106, v110, s28
    v_perm_b32 v147, v98, v102, s28
    buffer_store_dwordx4 v[144:147], v20, s[20:23], s34 offen sc1
    s_add_u32 s34, s34, 4096
    v_perm_b32 v148, v122, v126, s29
    v_perm_b32 v149, v114, v118, s29
    v_perm_b32 v150, v106, v110, s29
    v_perm_b32 v151, v98, v102, s29
    buffer_store_dwordx4 v[148:151], v20, s[20:23], s34 offen sc1
    s_add_u32 s34, s34, 4096
    v_perm_b32 v152, v123, v127, s28
    v_perm_b32 v153, v115, v119, s28
    v_perm_b32 v154, v107, v111, s28
    v_perm_b32 v155, v99, v103, s28
    buffer_store_dwordx4 v[152:155], v20, s[20:23], s34 offen sc1
    s_add_u32 s34, s34, 4096
    v_perm_b32 v156, v123, v127, s29
    v_perm_b32 v157, v115, v119, s29
    v_perm_b32 v158, v107, v111, s29
    v_perm_b32 v159, v99, v103, s29
    buffer_store_dwordx4 v[156:159], v20, s[20:23], s34 offen sc1
    s_add_u32 s34, s34, 233472
    v_dot2c_f32_bf16 v52, v96, v36
    v_dot2c_f32_bf16 v53, v100, v36
    v_dot2c_f32_bf16 v54, v104, v36
    v_dot2c_f32_bf16 v55, v108, v36
    v_dot2c_f32_bf16 v56, v112, v36
    v_dot2c_f32_bf16 v57, v116, v36
    v_dot2c_f32_bf16 v58, v120, v36
    v_dot2c_f32_bf16 v59, v124, v36
    v_dot2c_f32_bf16 v52, v97, v37
    v_dot2c_f32_bf16 v53, v101, v37
    v_dot2c_f32_bf16 v54, v105, v37
    v_dot2c_f32_bf16 v55, v109, v37
    v_dot2c_f32_bf16 v56, v113, v37
    v_dot2c_f32_bf16 v57, v117, v37
    v_dot2c_f32_bf16 v58, v121, v37
    v_dot2c_f32_bf16 v59, v125, v37
    v_dot2c_f32_bf16 v52, v98, v38
    v_dot2c_f32_bf16 v53, v102, v38
    v_dot2c_f32_bf16 v54, v106, v38
    v_dot2c_f32_bf16 v55, v110, v38
    v_dot2c_f32_bf16 v56, v114, v38
    v_dot2c_f32_bf16 v57, v118, v38
    v_dot2c_f32_bf16 v58, v122, v38
    v_dot2c_f32_bf16 v59, v126, v38
    v_dot2c_f32_bf16 v52, v99, v39
    v_dot2c_f32_bf16 v53, v103, v39
    v_dot2c_f32_bf16 v54, v107, v39
    v_dot2c_f32_bf16 v55, v111, v39
    v_dot2c_f32_bf16 v56, v115, v39
    v_dot2c_f32_bf16 v57, v119, v39
    v_dot2c_f32_bf16 v58, v123, v39
    v_dot2c_f32_bf16 v59, v127, v39
    ds_read_b128 v[96:99], v19 offset:24576
    ds_read_b128 v[100:103], v19 offset:24704
    ds_read_b128 v[104:107], v19 offset:24832
    ds_read_b128 v[108:111], v19 offset:24960
    ds_read_b128 v[112:115], v19 offset:25088
    ds_read_b128 v[116:119], v19 offset:25216
    ds_read_b128 v[120:123], v19 offset:25344
    ds_read_b128 v[124:127], v19 offset:25472
    s_waitcnt lgkmcnt(8)
    s_nop 0
    v_perm_b32 v128, v88, v92, s28
    v_perm_b32 v129, v80, v84, s28
    v_perm_b32 v130, v72, v76, s28
    v_perm_b32 v131, v64, v68, s28
    buffer_store_dwordx4 v[128:131], v20, s[20:23], s34 offen sc1
    s_add_u32 s34, s34, 4096
    v_perm_b32 v132, v88, v92, s29
    v_perm_b32 v133, v80, v84, s29
    v_perm_b32 v134, v72, v76, s29
    v_perm_b32 v135, v64, v68, s29
    buffer_store_dwordx4 v[132:135], v20, s[20:23], s34 offen sc1
    s_add_u32 s34, s34, 4096
    v_perm_b32 v136, v89, v93, s28
    v_perm_b32 v137, v81, v85, s28
    v_perm_b32 v138, v73, v77, s28
    v_perm_b32 v139, v65, v69, s28
    buffer_store_dwordx4 v[136:139], v20, s[20:23], s34 offen sc1
    s_add_u32 s34, s34, 4096
    v_perm_b32 v140, v89, v93, s29
    v_perm_b32 v141, v81, v85, s29
    v_perm_b32 v142, v73, v77, s29
    v_perm_b32 v143, v65, v69, s29
    buffer_store_dwordx4 v[140:143], v20, s[20:23], s34 offen sc1
    s_add_u32 s34, s34, 4096
    v_perm_b32 v144, v90, v94, s28
    v_perm_b32 v145, v82, v86, s28
    v_perm_b32 v146, v74, v78, s28
    v_perm_b32 v147, v66, v70, s28
    buffer_store_dwordx4 v[144:147], v20, s[20:23], s34 offen sc1
    s_add_u32 s34, s34, 4096
    v_perm_b32 v148, v90, v94, s29
    v_perm_b32 v149, v82, v86, s29
    v_perm_b32 v150, v74, v78, s29
    v_perm_b32 v151, v66, v70, s29
    buffer_store_dwordx4 v[148:151], v20, s[20:23], s34 offen sc1
    s_add_u32 s34, s34, 4096
    v_perm_b32 v152, v91, v95, s28
    v_perm_b32 v153, v83, v87, s28
    v_perm_b32 v154, v75, v79, s28
    v_perm_b32 v155, v67, v71, s28
    buffer_store_dwordx4 v[152:155], v20, s[20:23], s34 offen sc1
    s_add_u32 s34, s34, 4096
    v_perm_b32 v156, v91, v95, s29
    v_perm_b32 v157, v83, v87, s29
    v_perm_b32 v158, v75, v79, s29
    v_perm_b32 v159, v67, v71, s29
    buffer_store_dwordx4 v[156:159], v20, s[20:23], s34 offen sc1
    s_add_u32 s34, s34, 233472
    v_dot2c_f32_bf16 v52, v64, v40
    v_dot2c_f32_bf16 v53, v68, v40
    v_dot2c_f32_bf16 v54, v72, v40
    v_dot2c_f32_bf16 v55, v76, v40
    v_dot2c_f32_bf16 v56, v80, v40
    v_dot2c_f32_bf16 v57, v84, v40
    v_dot2c_f32_bf16 v58, v88, v40
    v_dot2c_f32_bf16 v59, v92, v40
    v_dot2c_f32_bf16 v52, v65, v41
    v_dot2c_f32_bf16 v53, v69, v41
    v_dot2c_f32_bf16 v54, v73, v41
    v_dot2c_f32_bf16 v55, v77, v41
    v_dot2c_f32_bf16 v56, v81, v41
    v_dot2c_f32_bf16 v57, v85, v41
    v_dot2c_f32_bf16 v58, v89, v41
    v_dot2c_f32_bf16 v59, v93, v41
    v_dot2c_f32_bf16 v52, v66, v42
    v_dot2c_f32_bf16 v53, v70, v42
    v_dot2c_f32_bf16 v54, v74, v42
    v_dot2c_f32_bf16 v55, v78, v42
    v_dot2c_f32_bf16 v56, v82, v42
    v_dot2c_f32_bf16 v57, v86, v42
    v_dot2c_f32_bf16 v58, v90, v42
    v_dot2c_f32_bf16 v59, v94, v42
    v_dot2c_f32_bf16 v52, v67, v43
    v_dot2c_f32_bf16 v53, v71, v43
    v_dot2c_f32_bf16 v54, v75, v43
    v_dot2c_f32_bf16 v55, v79, v43
    v_dot2c_f32_bf16 v56, v83, v43
    v_dot2c_f32_bf16 v57, v87, v43
    v_dot2c_f32_bf16 v58, v91, v43
    v_dot2c_f32_bf16 v59, v95, v43
    ds_read_b128 v[64:67], v19 offset:32768
    ds_read_b128 v[68:71], v19 offset:32896
    ds_read_b128 v[72:75], v19 offset:33024
    ds_read_b128 v[76:79], v19 offset:33152
    ds_read_b128 v[80:83], v19 offset:33280
    ds_read_b128 v[84:87], v19 offset:33408
    ds_read_b128 v[88:91], v19 offset:33536
    ds_read_b128 v[92:95], v19 offset:33664
    s_waitcnt lgkmcnt(8)
    s_nop 0
    v_perm_b32 v128, v120, v124, s28
    v_perm_b32 v129, v112, v116, s28
    v_perm_b32 v130, v104, v108, s28
    v_perm_b32 v131, v96, v100, s28
    buffer_store_dwordx4 v[128:131], v20, s[20:23], s34 offen sc1
    s_add_u32 s34, s34, 4096
    v_perm_b32 v132, v120, v124, s29
    v_perm_b32 v133, v112, v116, s29
    v_perm_b32 v134, v104, v108, s29
    v_perm_b32 v135, v96, v100, s29
    buffer_store_dwordx4 v[132:135], v20, s[20:23], s34 offen sc1
    s_add_u32 s34, s34, 4096
    v_perm_b32 v136, v121, v125, s28
    v_perm_b32 v137, v113, v117, s28
    v_perm_b32 v138, v105, v109, s28
    v_perm_b32 v139, v97, v101, s28
    buffer_store_dwordx4 v[136:139], v20, s[20:23], s34 offen sc1
    s_add_u32 s34, s34, 4096
    v_perm_b32 v140, v121, v125, s29
    v_perm_b32 v141, v113, v117, s29
    v_perm_b32 v142, v105, v109, s29
    v_perm_b32 v143, v97, v101, s29
    buffer_store_dwordx4 v[140:143], v20, s[20:23], s34 offen sc1
    s_add_u32 s34, s34, 4096
    v_perm_b32 v144, v122, v126, s28
    v_perm_b32 v145, v114, v118, s28
    v_perm_b32 v146, v106, v110, s28
    v_perm_b32 v147, v98, v102, s28
    buffer_store_dwordx4 v[144:147], v20, s[20:23], s34 offen sc1
    s_add_u32 s34, s34, 4096
    v_perm_b32 v148, v122, v126, s29
    v_perm_b32 v149, v114, v118, s29
    v_perm_b32 v150, v106, v110, s29
    v_perm_b32 v151, v98, v102, s29
    buffer_store_dwordx4 v[148:151], v20, s[20:23], s34 offen sc1
    s_add_u32 s34, s34, 4096
    v_perm_b32 v152, v123, v127, s28
    v_perm_b32 v153, v115, v119, s28
    v_perm_b32 v154, v107, v111, s28
    v_perm_b32 v155, v99, v103, s28
    buffer_store_dwordx4 v[152:155], v20, s[20:23], s34 offen sc1
    s_add_u32 s34, s34, 4096
    v_perm_b32 v156, v123, v127, s29
    v_perm_b32 v157, v115, v119, s29
    v_perm_b32 v158, v107, v111, s29
    v_perm_b32 v159, v99, v103, s29
    buffer_store_dwordx4 v[156:159], v20, s[20:23], s34 offen sc1
    s_add_u32 s34, s34, 233472
    v_dot2c_f32_bf16 v52, v96, v44
    v_dot2c_f32_bf16 v53, v100, v44
    v_dot2c_f32_bf16 v54, v104, v44
    v_dot2c_f32_bf16 v55, v108, v44
    v_dot2c_f32_bf16 v56, v112, v44
    v_dot2c_f32_bf16 v57, v116, v44
    v_dot2c_f32_bf16 v58, v120, v44
    v_dot2c_f32_bf16 v59, v124, v44
    v_dot2c_f32_bf16 v52, v97, v45
    v_dot2c_f32_bf16 v53, v101, v45
    v_dot2c_f32_bf16 v54, v105, v45
    v_dot2c_f32_bf16 v55, v109, v45
    v_dot2c_f32_bf16 v56, v113, v45
    v_dot2c_f32_bf16 v57, v117, v45
    v_dot2c_f32_bf16 v58, v121, v45
    v_dot2c_f32_bf16 v59, v125, v45
    v_dot2c_f32_bf16 v52, v98, v46
    v_dot2c_f32_bf16 v53, v102, v46
    v_dot2c_f32_bf16 v54, v106, v46
    v_dot2c_f32_bf16 v55, v110, v46
    v_dot2c_f32_bf16 v56, v114, v46
    v_dot2c_f32_bf16 v57, v118, v46
    v_dot2c_f32_bf16 v58, v122, v46
    v_dot2c_f32_bf16 v59, v126, v46
    v_dot2c_f32_bf16 v52, v99, v47
    v_dot2c_f32_bf16 v53, v103, v47
    v_dot2c_f32_bf16 v54, v107, v47
    v_dot2c_f32_bf16 v55, v111, v47
    v_dot2c_f32_bf16 v56, v115, v47
    v_dot2c_f32_bf16 v57, v119, v47
    v_dot2c_f32_bf16 v58, v123, v47
    v_dot2c_f32_bf16 v59, v127, v47
    s_waitcnt lgkmcnt(0)
    s_nop 0
    v_perm_b32 v128, v88, v92, s28
    v_perm_b32 v129, v80, v84, s28
    v_perm_b32 v130, v72, v76, s28
    v_perm_b32 v131, v64, v68, s28
    buffer_store_dwordx4 v[128:131], v20, s[20:23], s34 offen sc1
    s_add_u32 s34, s34, 4096
    v_perm_b32 v132, v88, v92, s29
    v_perm_b32 v133, v80, v84, s29
    v_perm_b32 v134, v72, v76, s29
    v_perm_b32 v135, v64, v68, s29
    buffer_store_dwordx4 v[132:135], v20, s[20:23], s34 offen sc1
    s_add_u32 s34, s34, 4096
    v_perm_b32 v136, v89, v93, s28
    v_perm_b32 v137, v81, v85, s28
    v_perm_b32 v138, v73, v77, s28
    v_perm_b32 v139, v65, v69, s28
    buffer_store_dwordx4 v[136:139], v20, s[20:23], s34 offen sc1
    s_add_u32 s34, s34, 4096
    v_perm_b32 v140, v89, v93, s29
    v_perm_b32 v141, v81, v85, s29
    v_perm_b32 v142, v73, v77, s29
    v_perm_b32 v143, v65, v69, s29
    buffer_store_dwordx4 v[140:143], v20, s[20:23], s34 offen sc1
    s_add_u32 s34, s34, 4096
    v_perm_b32 v144, v90, v94, s28
    v_perm_b32 v145, v82, v86, s28
    v_perm_b32 v146, v74, v78, s28
    v_perm_b32 v147, v66, v70, s28
    buffer_store_dwordx4 v[144:147], v20, s[20:23], s34 offen sc1
    s_add_u32 s34, s34, 4096
    v_perm_b32 v148, v90, v94, s29
    v_perm_b32 v149, v82, v86, s29
    v_perm_b32 v150, v74, v78, s29
    v_perm_b32 v151, v66, v70, s29
    buffer_store_dwordx4 v[148:151], v20, s[20:23], s34 offen sc1
    s_add_u32 s34, s34, 4096
    v_perm_b32 v152, v91, v95, s28
    v_perm_b32 v153, v83, v87, s28
    v_perm_b32 v154, v75, v79, s28
    v_perm_b32 v155, v67, v71, s28
    buffer_store_dwordx4 v[152:155], v20, s[20:23], s34 offen sc1
    s_add_u32 s34, s34, 4096
    v_perm_b32 v156, v91, v95, s29
    v_perm_b32 v157, v83, v87, s29
    v_perm_b32 v158, v75, v79, s29
    v_perm_b32 v159, v67, v71, s29
    buffer_store_dwordx4 v[156:159], v20, s[20:23], s34 offen sc1
    s_add_u32 s34, s34, 233472
    v_dot2c_f32_bf16 v52, v64, v48
    v_dot2c_f32_bf16 v53, v68, v48
    v_dot2c_f32_bf16 v54, v72, v48
    v_dot2c_f32_bf16 v55, v76, v48
    v_dot2c_f32_bf16 v56, v80, v48
    v_dot2c_f32_bf16 v57, v84, v48
    v_dot2c_f32_bf16 v58, v88, v48
    v_dot2c_f32_bf16 v59, v92, v48
    v_dot2c_f32_bf16 v52, v65, v49
    v_dot2c_f32_bf16 v53, v69, v49
    v_dot2c_f32_bf16 v54, v73, v49
    v_dot2c_f32_bf16 v55, v77, v49
    v_dot2c_f32_bf16 v56, v81, v49
    v_dot2c_f32_bf16 v57, v85, v49
    v_dot2c_f32_bf16 v58, v89, v49
    v_dot2c_f32_bf16 v59, v93, v49
    v_dot2c_f32_bf16 v52, v66, v50
    v_dot2c_f32_bf16 v53, v70, v50
    v_dot2c_f32_bf16 v54, v74, v50
    v_dot2c_f32_bf16 v55, v78, v50
    v_dot2c_f32_bf16 v56, v82, v50
    v_dot2c_f32_bf16 v57, v86, v50
    v_dot2c_f32_bf16 v58, v90, v50
    v_dot2c_f32_bf16 v59, v94, v50
    v_dot2c_f32_bf16 v52, v67, v51
    v_dot2c_f32_bf16 v53, v71, v51
    v_dot2c_f32_bf16 v54, v75, v51
    v_dot2c_f32_bf16 v55, v79, v51
    v_dot2c_f32_bf16 v56, v83, v51
    v_dot2c_f32_bf16 v57, v87, v51
    v_dot2c_f32_bf16 v58, v91, v51
    v_dot2c_f32_bf16 v59, v95, v51
    v_permlane32_swap_b32 v52, v56
    v_add_f32 v52, v52, v56
    v_permlane32_swap_b32 v53, v57
    v_add_f32 v53, v53, v57
    v_permlane32_swap_b32 v54, v58
    v_add_f32 v54, v54, v58
    v_permlane32_swap_b32 v55, v59
    v_add_f32 v55, v55, v59
    v_permlane16_swap_b32 v52, v54
    v_add_f32 v52, v52, v54
    v_permlane16_swap_b32 v53, v55
    v_add_f32 v53, v53, v55
    v_add_f32_dpp v52, v52, v52 row_ror:8 row_mask:0xf bank_mask:0xf
    s_nop 0
    v_add_f32_dpp v53, v53, v53 row_ror:8 row_mask:0xf bank_mask:0xf
    v_and_b32 v17, 1, v16
    v_cmp_eq_u32 vcc, 1, v17
    s_nop 1
    v_cndmask_b32 v22, v52, v53, vcc
    v_lshl_add_u32 v16, v18, 3, v16
    v_lshlrev_b32 v16, 2, v16
    s_lshl_b32 s5, s35, 1
    s_add_u32 s5, s5, s32
    s_lshl_b32 s5, s5, 8
    s_add_u32 s5, s5, 65536
    buffer_store_dword v22, v16, s[20:23], s5 offen sc1
    s_waitcnt vmcnt(0)
    v_readfirstlane_b32 s4, v13
    s_cmp_lt_u32 s4, 64
    s_cbranch_scc1 Lisl27
Liok26:
    s_mov_b32 s30, 136
    s_lshl_b32 s4, s30, 7
    v_mov_b32 v12, s4
    v_mov_b32 v13, 1
    s_mov_b64 exec, 1
    buffer_atomic_add v13, v12, s[20:23], 0 offen sc0 sc1
    s_mov_b64 exec, -1
    v_add_u32 v12, 182, v0
    v_lshlrev_b32 v12, 7, v12
    v_mov_b32 v14, 1
    s_waitcnt vmcnt(0)
    v_readfirstlane_b32 s4, v13
    s_cmp_lg_u32 s4, 63
    s_cbranch_scc1 Lsl30
    s_mov_b64 exec, 255
    buffer_store_dword v14, v12, s[20:23], 0 offen sc1
    s_mov_b64 exec, -1
Lsl30:
    s_setprio 0
LPfl:
    s_cmp_ge_u32 s6, 1280
    s_cbranch_scc1 LPdone
LPloop:
    buffer_load_dword v20, v3, s[8:11], s6 offen
    buffer_load_dword v21, v5, s[12:15], s7 offen
    buffer_load_dword v22, v4, s[8:11], s6 offen
    buffer_load_dword v23, v5, s[16:19], s7 offen
    s_add_u32 s7, s7, 196608
    s_add_u32 s6, s6, 128
    s_waitcnt vmcnt(4)
    s_cmp_lt_u32 s6, 1280
    s_cbranch_scc1 LPloop
LPdone:
    s_lshr_b32 s6, s66, 1
    s_lshl_b32 s6, s6, 3
    s_and_b32 s7, s67, 7
    s_add_u32 s31, s6, s7
    s_and_b32 s6, s66, 1
    s_lshl_b32 s6, s6, 2
    s_lshr_b32 s7, s67, 3
    s_add_u32 s32, s6, s7
    s_add_u32 s6, s66, 182
    s_lshl_b32 s4, s6, 7
    v_mov_b32 v12, s4
    v_mov_b32 v13, 1
    s_mov_b32 s5, 0
Lpl31:
    buffer_load_dword v14, v12, s[20:23], 0 offen sc1
    s_add_u32 s5, s5, 1
    s_waitcnt vmcnt(0)
    v_cmp_lt_u32 vcc, v14, v13
    s_cbranch_vccz Lple32
    s_sleep 4
    s_cmp_lt_u32 s5, 1048576
    s_cbranch_scc1 Lpl31
Lple32:
    s_mov_b32 s5, 0
Lls33:
    ds_read_b32 v12, v10 offset:416
    s_add_u32 s5, s5, 1
    s_waitcnt lgkmcnt(0)
    v_readfirstlane_b32 s4, v12
    s_cmp_ge_u32 s4, 1
    s_cbranch_scc1 Llse34
    s_sleep 1
    s_cmp_lt_u32 s5, 1048576
    s_cbranch_scc1 Lls33
Llse34:
    v_lshlrev_b32 v2, 4, v0
    s_mul_i32 s4, s66, 80
    s_and_b32 s5, s67, 7
    s_lshl_b32 s5, s5, 3
    s_add_u32 s4, s4, s5
    s_lshl_b32 s4, s4, 12
    s_add_u32 s4, s4, 131072
    s_mov_b32 m0, 25984
    s_nop 0
    buffer_load_dwordx4 v2, s[20:23], s4 offen offset:0 sc1 lds
    buffer_load_dwordx4 v2, s[20:23], s4 offen offset:1024 sc1 lds
    buffer_load_dwordx4 v2, s[20:23], s4 offen offset:2048 sc1 lds
    buffer_load_dwordx4 v2, s[20:23], s4 offen offset:3072 sc1 lds
    s_add_u32 s4, s4, 4096
    s_mov_b32 m0, 131584
    s_nop 0
    buffer_load_dwordx4 v2, s[20:23], s4 offen offset:0 sc1 lds
    buffer_load_dwordx4 v2, s[20:23], s4 offen offset:1024 sc1 lds
    buffer_load_dwordx4 v2, s[20:23], s4 offen offset:2048 sc1 lds
    buffer_load_dwordx4 v2, s[20:23], s4 offen offset:3072 sc1 lds
    s_add_u32 s4, s4, 4096
    s_mov_b32 m0, 145024
    s_nop 0
    buffer_load_dwordx4 v2, s[20:23], s4 offen offset:0 sc1 lds
    buffer_load_dwordx4 v2, s[20:23], s4 offen offset:1024 sc1 lds
    buffer_load_dwordx4 v2, s[20:23], s4 offen offset:2048 sc1 lds
    buffer_load_dwordx4 v2, s[20:23], s4 offen offset:3072 sc1 lds
    s_add_u32 s4, s4, 4096
    s_mov_b32 m0, 158464
    s_nop 0
    buffer_load_dwordx4 v2, s[20:23], s4 offen offset:0 sc1 lds
    buffer_load_dwordx4 v2, s[20:23], s4 offen offset:1024 sc1 lds
    buffer_load_dwordx4 v2, s[20:23], s4 offen offset:2048 sc1 lds
    buffer_load_dwordx4 v2, s[20:23], s4 offen offset:3072 sc1 lds
    s_add_u32 s4, s4, 4096
    s_mov_b32 m0, 163552
    s_mov_b64 exec, 1
    buffer_load_dword off, s[24:27], s26 lds
    s_mov_b64 exec, -1
    s_add_u32 s6, s66, 190
    s_lshl_b32 s4, s6, 7
    v_mov_b32 v12, s4
    v_mov_b32 v13, 1
    s_mov_b32 s5, 0
Lpl35:
    buffer_load_dword v14, v12, s[20:23], 0 offen sc1
    s_add_u32 s5, s5, 1
    s_waitcnt vmcnt(0)
    v_cmp_lt_u32 vcc, v14, v13
    s_cbranch_vccz Lple36
    s_sleep 4
    s_cmp_lt_u32 s5, 1048576
    s_cbranch_scc1 Lpl35
Lple36:
    v_mov_b32 v11, 1
    s_mov_b64 exec, 1
    ds_write_b32 v10, v11 offset:404
    s_mov_b64 exec, -1
    s_mul_i32 s34, s66, 80
    s_and_b32 s5, s67, 7
    s_lshl_b32 s5, s5, 3
    s_add_u32 s34, s34, s5
    s_lshl_b32 s4, s34, 1
    s_load_dword s17, s[48:49], s4
    s_mov_b32 s5, 0
Lzs37:
    ds_read_b32 v12, v10 offset:320
    s_add_u32 s5, s5, 1
    s_waitcnt lgkmcnt(0)
    v_cmp_eq_u32 vcc, 0, v12
    s_cbranch_vccnz Lzse38
    s_sleep 1
    s_cmp_lt_u32 s5, 1048576
    s_cbranch_scc1 Lzs37
Lzse38:
    s_lshl_b32 s17, s17, 16
    s_mov_b32 s33, 17280
    v_mov_b32 v15, 163200
    v_and_b32 v2, 15, v0
    v_lshrrev_b32 v3, 4, v0
    s_branch LSconv
LPlast:
    v_lshlrev_b32_e64 v2, 4, v0
    s_mul_i32 s7, s32, 245760
    s_add_u32 s7, s7, 5404672
    s_mov_b32 m0, 16384
    s_add_u32 s6, s7, 16384
    buffer_load_dwordx4 v2, s[20:23], s6 offen offset:0 sc1 lds
    buffer_load_dwordx4 v2, s[20:23], s6 offen offset:1024 sc1 lds
    buffer_load_dwordx4 v2, s[20:23], s6 offen offset:2048 sc1 lds
    buffer_load_dwordx4 v2, s[20:23], s6 offen offset:3072 sc1 lds
    s_mov_b32 m0, 20480
    s_add_u32 s6, s7, 20480
    buffer_load_dwordx4 v2, s[20:23], s6 offen offset:0 sc1 lds
    buffer_load_dwordx4 v2, s[20:23], s6 offen offset:1024 sc1 lds
    buffer_load_dwordx4 v2, s[20:23], s6 offen offset:2048 sc1 lds
    buffer_load_dwordx4 v2, s[20:23], s6 offen offset:3072 sc1 lds
    s_mov_b32 m0, 24576
    s_add_u32 s6, s7, 24576
    buffer_load_dwordx4 v2, s[20:23], s6 offen offset:0 sc1 lds
    buffer_load_dwordx4 v2, s[20:23], s6 offen offset:1024 sc1 lds
    buffer_load_dwordx4 v2, s[20:23], s6 offen offset:2048 sc1 lds
    buffer_load_dwordx4 v2, s[20:23], s6 offen offset:3072 sc1 lds
    s_mov_b32 m0, 28672
    s_add_u32 s6, s7, 28672
    buffer_load_dwordx4 v2, s[20:23], s6 offen offset:0 sc1 lds
    buffer_load_dwordx4 v2, s[20:23], s6 offen offset:1024 sc1 lds
    s_mov_b32 m0, 163560
    s_mov_b64 exec, 1
    buffer_load_dword off, s[24:27], s26 lds
    s_mov_b64 exec, -1
    s_mov_b32 m0, 163564
    s_mov_b64 exec, 1
    buffer_load_dword off, s[24:27], s26 lds
    s_mov_b64 exec, -1
    s_waitcnt vmcnt(0)
    s_branch LPlastr
LPret:
    v_mov_b32 v10, 163200
    s_mov_b32 s5, 0
Lls39:
    ds_read_b32 v7, v10 offset:392
    s_add_u32 s5, s5, 1
    s_waitcnt lgkmcnt(0)
    v_readfirstlane_b32 s4, v7
    s_cmp_ge_u32 s4, 1
    s_cbranch_scc1 Llse40
    s_sleep 4
    s_cmp_lt_u32 s5, 1048576
    s_cbranch_scc1 Lls39
Llse40:
    s_branch Lstagea
LJ:
    v_lshlrev_b32 v2, 4, v0
    v_mov_b32 v10, 163200
    s_waitcnt lgkmcnt(0)
    s_mov_b64 s[20:21], s[64:65]
    s_mov_b32 s22, 0x1080000
    s_mov_b32 s23, 0x20000
    s_mov_b64 s[24:25], s[62:63]
    s_mov_b32 s26, 0x100
    s_mov_b32 s27, 0x20000
    s_lshr_b32 s6, s66, 1
    s_lshl_b32 s6, s6, 3
    s_and_b32 s7, s67, 7
    s_add_u32 s31, s6, s7
    s_and_b32 s6, s66, 1
    s_lshl_b32 s6, s6, 2
    s_lshr_b32 s7, s67, 3
    s_add_u32 s32, s6, s7
    s_mov_b32 s5, 0
Lzs41:
    ds_read_b32 v12, v10 offset:192
    s_add_u32 s5, s5, 1
    s_waitcnt lgkmcnt(0)
    v_cmp_eq_u32 vcc, 0, v12
    s_cbranch_vccnz Lzse42
    s_sleep 8
    s_cmp_lt_u32 s5, 1048576
    s_cbranch_scc1 Lzs41
Lzse42:
    v_mov_b32 v12, 0
    s_mov_b32 s5, 0
Lwi43:
    buffer_load_dword v13, v12, s[24:27], 0 offen sc1
    s_add_u32 s5, s5, 1
    s_waitcnt vmcnt(0)
    v_readfirstlane_b32 s4, v13
    s_cmp_ge_u32 s4, 64
    s_cbranch_scc1 Lwie44
    s_sleep 4
    s_cmp_lt_u32 s5, 1048576
    s_cbranch_scc1 Lwi43
Lwie44:
    s_mov_b32 s5, 0
Lzs45:
    ds_read_b32 v12, v10 offset:256
    s_add_u32 s5, s5, 1
    s_waitcnt lgkmcnt(0)
    v_cmp_eq_u32 vcc, 0, v12
    s_cbranch_vccnz Lzse46
    s_sleep 8
    s_cmp_lt_u32 s5, 1048576
    s_cbranch_scc1 Lzs45
Lzse46:
    s_add_u32 s6, s66, 190
    s_lshl_b32 s4, s6, 7
    v_mov_b32 v12, s4
    v_mov_b32 v13, 1
    s_mov_b32 s5, 0
Lpl47:
    buffer_load_dword v14, v12, s[20:23], 0 offen sc1
    s_add_u32 s5, s5, 1
    s_waitcnt vmcnt(0)
    v_cmp_lt_u32 vcc, v14, v13
    s_cbranch_vccz Lple48
    s_sleep 4
    s_cmp_lt_u32 s5, 1048576
    s_cbranch_scc1 Lpl47
Lple48:
    v_mov_b32 v11, 1
    s_mov_b64 exec, 1
    ds_write_b32 v10, v11 offset:404
    s_mov_b64 exec, -1
    s_add_u32 s4, s66, 182
    s_mul_i32 s5, s66, 24
    s_add_u32 s5, s5, s67
    s_add_u32 s5, s5, 264
    v_mov_b32 v12, s4
    v_writelane_b32 v12, s5, 0
    v_lshlrev_b32 v12, 7, v12
    s_mov_b32 s5, 0
Lzs49:
    ds_read_b32 v14, v10 offset:256
    s_add_u32 s5, s5, 1
    s_waitcnt lgkmcnt(0)
    v_cmp_eq_u32 vcc, 0, v14
    s_cbranch_vccnz Lzse50
    s_sleep 4
    s_cmp_lt_u32 s5, 1048576
    s_cbranch_scc1 Lzs49
Lzse50:
    s_mov_b32 s5, 0
Lpl51:
    buffer_load_dword v14, v12, s[20:23], 0 offen sc1
    s_add_u32 s5, s5, 1
    s_waitcnt vmcnt(0)
    v_cmp_lt_u32 vcc, v14, v13
    s_cbranch_vccz Lple52
    s_sleep 4
    s_cmp_lt_u32 s5, 1048576
    s_cbranch_scc1 Lpl51
Lple52:
    s_lshr_b32 s4, s67, 1
    s_lshl_b32 s4, s4, 3
    s_and_b32 s5, s67, 1
    s_lshl_b32 s5, s5, 1
    s_add_u32 s4, s4, s5
    s_add_u32 s4, s4, 4
    s_lshl_b32 s5, s67, 1
    s_add_u32 s5, s5, 32
    s_cmp_lt_u32 s67, 16
    s_cselect_b32 s4, s4, s5
    s_mul_i32 s16, s66, 80
    s_add_u32 s16, s16, s4
    s_lshl_b32 s16, s16, 12
    s_add_u32 s16, s16, 131072
    s_mul_i32 s17, s66, 24
    s_add_u32 s17, s17, s67
    s_lshl_b32 s17, s17, 12
    s_add_u32 s17, s17, 13631488
    s_mov_b32 m0, 147456
    s_nop 0
    buffer_load_dwordx4 v2, s[20:23], s17 offen sc1 lds
    s_mov_b64 exec, 0xffffff
    buffer_load_dwordx4 v2, s[20:23], s17 offen offset:1024 sc1 lds
    s_mov_b64 exec, -1
    s_add_u32 s17, s17, 2048
    s_mov_b32 m0, 156160
    s_nop 0
    buffer_load_dwordx4 v2, s[20:23], s16 offen offset:0 sc1 lds
    buffer_load_dwordx4 v2, s[20:23], s16 offen offset:1024 sc1 lds
    buffer_load_dwordx4 v2, s[20:23], s16 offen offset:2048 sc1 lds
    buffer_load_dwordx4 v2, s[20:23], s16 offen offset:3072 sc1 lds
    s_add_u32 s16, s16, 4096
    s_mov_b32 m0, 163552
    s_mov_b64 exec, 1
    buffer_load_dword off, s[24:27], s26 lds
    s_mov_b64 exec, -1
    s_mov_b32 s5, 0
Lzs53:
    ds_read_b128 v[12:15], v10 offset:288
    s_add_u32 s5, s5, 1
    s_waitcnt lgkmcnt(0)
    v_or3_b32 v12, v12, v13, v14
    v_or_b32 v12, v12, v15
    v_cmp_eq_u32 vcc, 0, v12
    s_cbranch_vccnz Lzse54
    s_sleep 1
    s_cmp_lt_u32 s5, 1048576
    s_cbranch_scc1 Lzs53
Lzse54:
    s_mov_b32 m0, 122880
    s_nop 0
    buffer_load_dwordx4 v2, s[20:23], s17 offen sc1 lds
    s_mov_b64 exec, 0xffffff
    buffer_load_dwordx4 v2, s[20:23], s17 offen offset:1024 sc1 lds
    s_mov_b64 exec, -1
    s_add_u32 s17, s17, 2048
    s_mov_b32 m0, 131584
    s_nop 0
    buffer_load_dwordx4 v2, s[20:23], s16 offen offset:0 sc1 lds
    buffer_load_dwordx4 v2, s[20:23], s16 offen offset:1024 sc1 lds
    buffer_load_dwordx4 v2, s[20:23], s16 offen offset:2048 sc1 lds
    buffer_load_dwordx4 v2, s[20:23], s16 offen offset:3072 sc1 lds
    s_add_u32 s16, s16, 4096
    s_mov_b32 s33, 122880
    s_waitcnt vmcnt(0)
    s_mov_b32 s5, 0
Lzs55:
    ds_read_b128 v[12:15], v10 offset:304
    s_add_u32 s5, s5, 1
    s_waitcnt lgkmcnt(0)
    v_or3_b32 v12, v12, v13, v14
    v_or_b32 v12, v12, v15
    v_cmp_eq_u32 vcc, 0, v12
    s_cbranch_vccnz Lzse56
    s_sleep 1
    s_cmp_lt_u32 s5, 1048576
    s_cbranch_scc1 Lzs55
Lzse56:
    s_setprio 3
    v_mov_b32 v15, 163200
    s_branch Lexp
LJret:
    v_mov_b32 v10, 163200
    s_mov_b32 s5, 0
Lls57:
    ds_read_b32 v12, v10 offset:456
    s_add_u32 s5, s5, 1
    s_waitcnt lgkmcnt(0)
    v_readfirstlane_b32 s4, v12
    s_cmp_ge_u32 s4, 2
    s_cbranch_scc1 Llse58
    s_sleep 1
    s_cmp_lt_u32 s5, 1048576
    s_cbranch_scc1 Lls57
Llse58:
Lstagea:
    s_mov_b32 s5, 0
Lzs59:
    ds_read_b128 v[12:15], v10 offset:320
    s_add_u32 s5, s5, 1
    s_waitcnt lgkmcnt(0)
    v_or3_b32 v12, v12, v13, v14
    v_or_b32 v12, v12, v15
    v_cmp_eq_u32 vcc, 0, v12
    s_cbranch_vccnz Lzse60
    s_sleep 1
    s_cmp_lt_u32 s5, 1048576
    s_cbranch_scc1 Lzs59
Lzse60:
    s_lshl_b32 s4, s32, 3
    s_add_u32 s4, s4, s66
    s_add_u32 s4, s4, 198
    s_lshl_b32 s4, s4, 7
    v_mov_b32 v4, s4
    v_mov_b32 v5, 1
    s_mov_b32 s5, 0
Lpl61:
    buffer_load_dword v6, v4, s[20:23], 0 offen sc1
    s_add_u32 s5, s5, 1
    s_waitcnt vmcnt(0)
    v_cmp_lt_u32 vcc, v6, v5
    s_cbranch_vccz Lple62
    s_sleep 4
    s_cmp_lt_u32 s5, 1048576
    s_cbranch_scc1 Lpl61
Lple62:
    v_lshrrev_b32 v4, 3, v0
    v_lshlrev_b32 v4, 12, v4
    v_and_b32 v5, 7, v0
    v_lshl_add_u32 v4, v5, 4, v4
    s_mul_i32 s5, s32, 327680
    s_lshl_b32 s6, s31, 7
    s_add_u32 s5, s5, s6
    s_add_u32 s5, s5, 131072
    v_lshlrev_b32 v6, 2, v0
    s_lshl_b32 s6, s31, 9
    s_add_u32 s6, s6, 65536
    s_mov_b32 m0, 122880
    s_nop 0
    s_nop 0
    buffer_load_dwordx4 v4, s[20:23], s5 offen sc1 lds
    s_add_u32 m0, m0, 1024
    s_add_u32 s5, s5, 32768
    buffer_load_dwordx4 v4, s[20:23], s5 offen sc1 lds
    s_add_u32 m0, m0, 1024
    s_add_u32 s5, s5, 32768
    buffer_load_dwordx4 v4, s[20:23], s5 offen sc1 lds
    s_add_u32 m0, m0, 1024
    s_add_u32 s5, s5, 32768
    buffer_load_dwordx4 v4, s[20:23], s5 offen sc1 lds
    s_add_u32 m0, m0, 1024
    s_add_u32 s5, s5, 32768
    buffer_load_dwordx4 v4, s[20:23], s5 offen sc1 lds
    s_add_u32 m0, m0, 1024
    s_add_u32 s5, s5, 32768
    buffer_load_dwordx4 v4, s[20:23], s5 offen sc1 lds
    s_add_u32 m0, m0, 1024
    s_add_u32 s5, s5, 32768
    buffer_load_dwordx4 v4, s[20:23], s5 offen sc1 lds
    s_add_u32 m0, m0, 1024
    s_add_u32 s5, s5, 32768
    buffer_load_dwordx4 v4, s[20:23], s5 offen sc1 lds
    s_add_u32 m0, m0, 1024
    s_add_u32 s5, s5, 32768
    buffer_load_dwordx4 v4, s[20:23], s5 offen sc1 lds
    s_add_u32 m0, m0, 1024
    s_add_u32 s5, s5, 32768
    buffer_load_dwordx4 v4, s[20:23], s5 offen sc1 lds
    s_add_u32 m0, m0, 1024
    s_add_u32 s5, s5, 32768
    buffer_load_dword v6, s[20:23], s6 offen sc1 lds
    buffer_load_dword v6, s[20:23], s6 offen offset:256 sc1 lds
    s_waitcnt vmcnt(0)
    s_endpgm
LS6:
    s_waitcnt lgkmcnt(0)
    v_mov_b32 v10, 163200
    s_mov_b64 s[20:21], s[64:65]
    s_mov_b32 s22, 0x1080000
    s_mov_b32 s23, 0x20000
    s_mov_b64 s[24:25], s[62:63]
    s_mov_b32 s26, 0x100
    s_mov_b32 s27, 0x20000
    s_mov_b32 s5, 0
Lzs63:
    ds_read_b32 v12, v10 offset:288
    s_add_u32 s5, s5, 1
    s_waitcnt lgkmcnt(0)
    v_cmp_eq_u32 vcc, 0, v12
    s_cbranch_vccnz Lzse64
    s_sleep 16
    s_cmp_lt_u32 s5, 1048576
    s_cbranch_scc1 Lzs63
Lzse64:
    s_mov_b32 s5, 0
Lzs65:
    ds_read_b32 v12, v10 offset:352
    s_add_u32 s5, s5, 1
    s_waitcnt lgkmcnt(0)
    v_cmp_eq_u32 vcc, 0, v12
    s_cbranch_vccnz Lzse66
    s_sleep 1
    s_cmp_lt_u32 s5, 1048576
    s_cbranch_scc1 Lzs65
Lzse66:
    s_mov_b32 s5, 0
Lzs67:
    ds_read_b128 v[12:15], v10 offset:304
    s_add_u32 s5, s5, 1
    s_waitcnt lgkmcnt(0)
    v_or3_b32 v12, v12, v13, v14
    v_or_b32 v12, v12, v15
    v_cmp_eq_u32 vcc, 0, v12
    s_cbranch_vccnz Lzse68
    s_sleep 1
    s_cmp_lt_u32 s5, 1048576
    s_cbranch_scc1 Lzs67
Lzse68:
    s_setprio 3
    s_mov_b32 s33, 147456
    v_mov_b32 v15, 163200
    s_branch Lexp
LS:
    s_and_b32 s7, s67, 7
    s_mul_i32 s35, s7, 3
    s_and_b32 s4, s3, 3
    s_add_u32 s35, s35, s4
    s_sub_u32 s35, s35, 1
    s_lshr_b32 s4, s35, 1
    s_lshl_b32 s4, s4, 3
    s_and_b32 s5, s35, 1
    s_lshl_b32 s5, s5, 1
    s_add_u32 s4, s4, s5
    s_add_u32 s4, s4, 4
    s_lshl_b32 s5, s35, 1
    s_add_u32 s5, s5, 32
    s_cmp_lt_u32 s35, 16
    s_cselect_b32 s4, s4, s5
    s_mul_i32 s28, s66, 80
    s_add_u32 s28, s28, s4
    s_mul_i32 s34, s66, 80
    s_lshl_b32 s4, s7, 3
    s_add_u32 s34, s34, s4
    s_and_b32 s4, s3, 3
    s_add_u32 s34, s34, s4
    s_mul_i32 s32, s3, 13440
    s_add_u32 s32, s32, 55680
    s_lshr_b32 s5, s3, 2
    s_add_u32 s28, s28, s5
    s_sub_u32 s33, s3, s5
    s_lshl_b32 s33, s33, 11
    s_sub_u32 s33, s33, 2048
    s_mov_b32 s30, s5
    s_cmp_eq_u32 s3, 0
    s_cselect_b32 s28, s34, s28
    s_cselect_b32 s33, 17280, s33
    s_sub_u32 s31, s3, s5
    s_mul_i32 s31, s31, 4608
    s_add_u32 s31, s31, 90112
    v_lshlrev_b32 v14, 4, v0
    s_lshl_b32 s4, s34, 1
    s_and_b32 s4, s4, 0xfffc
    s_lshl_b32 s5, s28, 1
    s_and_b32 s5, s5, 0xfffc
    s_mul_i32 s6, s28, 384
    s_mul_i32 s7, s34, 384
    s_mov_b32 s14, 245760
    s_mov_b32 s15, 0x20000
    s_add_u32 m0, s33, 0
    s_mov_b64 exec, 0xffffff
    s_waitcnt lgkmcnt(0)
    s_mov_b64 s[12:13], s[38:39]
    buffer_load_dwordx4 v14, s[12:15], s6 offen nt lds
    s_add_u32 m0, m0, 384
    s_mov_b64 s[12:13], s[40:41]
    buffer_load_dwordx4 v14, s[12:15], s6 offen nt lds
    s_add_u32 m0, m0, 384
    s_mov_b64 s[12:13], s[42:43]
    buffer_load_dwordx4 v14, s[12:15], s6 offen nt lds
    s_add_u32 m0, m0, 384
    s_mov_b64 s[12:13], s[44:45]
    buffer_load_dwordx4 v14, s[12:15], s6 offen nt lds
    s_add_u32 m0, m0, 384
    s_load_dword s29, s[46:47], s4
    s_load_dword s17, s[48:49], s4
    s_load_dword s18, s[46:47], s5
    s_setprio 1
    s_cmp_eq_u32 s30, 0
    s_cbranch_scc1 LSnb
    s_setprio 2
    s_add_u32 m0, s32, 0
    s_mov_b64 s[12:13], s[38:39]
    buffer_load_dwordx4 v14, s[12:15], s7 offen nt lds
    s_add_u32 m0, m0, 384
    s_mov_b64 s[12:13], s[40:41]
    buffer_load_dwordx4 v14, s[12:15], s7 offen nt lds
    s_add_u32 m0, m0, 384
    s_mov_b64 s[12:13], s[42:43]
    buffer_load_dwordx4 v14, s[12:15], s7 offen nt lds
    s_add_u32 m0, m0, 384
    s_mov_b64 s[12:13], s[44:45]
    buffer_load_dwordx4 v14, s[12:15], s7 offen nt lds
    s_add_u32 m0, m0, 384
LSnb:
    s_mov_b64 exec, -1
    s_mov_b64 s[20:21], s[64:65]
    s_mov_b32 s22, 0x1080000
    s_mov_b32 s23, 0x20000
    s_mov_b64 s[24:25], s[62:63]
    s_mov_b32 s26, 0x100
    s_mov_b32 s27, 0x20000
    s_cmp_eq_u32 s3, 0
    s_cbranch_scc1 LSw0
    s_cmp_lg_u32 s3, 1
    s_cbranch_scc1 LSni
    v_mov_b32 v16, 0
    v_mov_b32 v17, 0
    v_mov_b32 v18, 0
    v_mov_b32 v19, 0
    s_sub_u32 s4, s2, 192
    s_lshl_b32 s4, s4, 10
    buffer_store_dwordx4 v[16:19], v14, s[20:23], s4 offen sc1
LSni:
    s_barrier
    s_waitcnt vmcnt(0)
    s_cmp_lg_u32 s3, 1
    s_cbranch_scc1 LSn2
    v_mov_b32 v17, 1
    s_mov_b64 exec, 1
    buffer_atomic_add v17, off, s[24:27], 0 sc1
    s_mov_b64 exec, -1
    s_branch LSn2
LSw0:
    s_barrier
    s_mov_b64 s[8:9], s[56:57]
    s_mov_b32 s10, 0x1e0000
    s_mov_b32 s11, 0x20000
    s_sub_u32 s4, s2, 192
    s_mul_i32 s4, s4, 30720
    s_mov_b32 m0, 125952
    s_nop 0
    buffer_load_dwordx4 v14, s[8:11], s4 offen offset:0 nt lds
    buffer_load_dwordx4 v14, s[8:11], s4 offen offset:1024 nt lds
    buffer_load_dwordx4 v14, s[8:11], s4 offen offset:2048 nt lds
    buffer_load_dwordx4 v14, s[8:11], s4 offen offset:3072 nt lds
    s_add_u32 m0, m0, 4096
    s_add_u32 s4, s4, 4096
    buffer_load_dwordx4 v14, s[8:11], s4 offen offset:0 nt lds
    buffer_load_dwordx4 v14, s[8:11], s4 offen offset:1024 nt lds
    buffer_load_dwordx4 v14, s[8:11], s4 offen offset:2048 nt lds
    buffer_load_dwordx4 v14, s[8:11], s4 offen offset:3072 nt lds
    s_add_u32 m0, m0, 4096
    s_add_u32 s4, s4, 4096
    buffer_load_dwordx4 v14, s[8:11], s4 offen offset:0 nt lds
    buffer_load_dwordx4 v14, s[8:11], s4 offen offset:1024 nt lds
    s_add_u32 s4, s4, 2048
    s_mov_b32 m0, 139392
    s_nop 0
    s_nop 0
    buffer_load_dwordx4 v14, s[8:11], s4 offen offset:0 nt lds
    buffer_load_dwordx4 v14, s[8:11], s4 offen offset:1024 nt lds
    buffer_load_dwordx4 v14, s[8:11], s4 offen offset:2048 nt lds
    buffer_load_dwordx4 v14, s[8:11], s4 offen offset:3072 nt lds
    s_add_u32 m0, m0, 4096
    s_add_u32 s4, s4, 4096
    buffer_load_dwordx4 v14, s[8:11], s4 offen offset:0 nt lds
    buffer_load_dwordx4 v14, s[8:11], s4 offen offset:1024 nt lds
    buffer_load_dwordx4 v14, s[8:11], s4 offen offset:2048 nt lds
    buffer_load_dwordx4 v14, s[8:11], s4 offen offset:3072 nt lds
    s_add_u32 m0, m0, 4096
    s_add_u32 s4, s4, 4096
    buffer_load_dwordx4 v14, s[8:11], s4 offen offset:0 nt lds
    buffer_load_dwordx4 v14, s[8:11], s4 offen offset:1024 nt lds
    s_add_u32 s4, s4, 2048
    s_mov_b32 m0, 152832
    s_nop 0
    s_nop 0
    buffer_load_dwordx4 v14, s[8:11], s4 offen offset:0 nt lds
    buffer_load_dwordx4 v14, s[8:11], s4 offen offset:1024 nt lds
    buffer_load_dwordx4 v14, s[8:11], s4 offen offset:2048 nt lds
    buffer_load_dwordx4 v14, s[8:11], s4 offen offset:3072 nt lds
    s_add_u32 m0, m0, 4096
    s_add_u32 s4, s4, 4096
    buffer_load_dwordx4 v14, s[8:11], s4 offen offset:0 nt lds
    buffer_load_dwordx4 v14, s[8:11], s4 offen offset:1024 nt lds
    buffer_load_dwordx4 v14, s[8:11], s4 offen offset:2048 nt lds
    buffer_load_dwordx4 v14, s[8:11], s4 offen offset:3072 nt lds
    s_add_u32 m0, m0, 4096
    s_add_u32 s4, s4, 4096
    buffer_load_dwordx4 v14, s[8:11], s4 offen offset:0 nt lds
    buffer_load_dwordx4 v14, s[8:11], s4 offen offset:1024 nt lds
    s_add_u32 s4, s4, 2048
    s_waitcnt vmcnt(30)
LSn2:
    s_waitcnt lgkmcnt(0)
    s_bitcmp1_b32 s34, 0
    s_cselect_b32 s4, 0, 16
    s_lshl_b32 s29, s29, s4
    s_and_b32 s29, s29, 0xffff0000
    s_bitcmp1_b32 s34, 0
    s_cselect_b32 s4, 0, 16
    s_lshl_b32 s17, s17, s4
    s_and_b32 s17, s17, 0xffff0000
    s_bitcmp1_b32 s28, 0
    s_cselect_b32 s4, 0, 16
    s_lshl_b32 s18, s18, s4
    s_nop 0
    s_and_b32 s18, s18, 0xffff0000
    s_mov_b32 s14, 0x3fb8aa3b
    s_mov_b32 s15, 0x32a57060
LSround:
    v_lshl_add_u32 v14, v0, 1, s33
    ds_read_u16 v4, v14 offset:768
    ds_read_u16 v8, v14 offset:896
    ds_read_u16 v12, v14 offset:1024
    ds_read_u16 v5, v14 offset:1152
    ds_read_u16 v9, v14 offset:1280
    ds_read_u16 v13, v14 offset:1408
    ds_read_u16 v2, v14 offset:0
    ds_read_u16 v6, v14 offset:128
    ds_read_u16 v10, v14 offset:256
    ds_read_u16 v3, v14 offset:384
    ds_read_u16 v7, v14 offset:512
    ds_read_u16 v11, v14 offset:640
    v_and_b32 v36, 15, v0
    v_mul_u32_u24 v36, 288, v36
    v_and_b32 v15, 48, v0
    v_add3_u32 v36, v15, v36, s31
    s_sub_u32 m0, s31, 57344
    v_mov_b32 v58, 0x3c00
    v_mov_b32 v37, s18
    v_mul_f32 v38, s14, v37
    v_fma_f32 v39, s14, v37, -v38
    v_exp_f32 v38, v38
    v_fmac_f32 v39, s15, v37
    v_mul_f32 v39, 0x3f317218, v39
    v_fmac_f32 v38, v38, v39
    v_cvt_pk_bf16_f32 v38, v38, v38
    v_lshlrev_b32 v37, 16, v38
    s_waitcnt lgkmcnt(0)
    v_lshlrev_b32 v4, 16, v4
    v_lshlrev_b32 v5, 16, v5
    v_lshlrev_b32 v8, 16, v8
    v_lshlrev_b32 v9, 16, v9
    v_lshlrev_b32 v12, 16, v12
    v_lshlrev_b32_e64 v13, 16, v13
    v_max3_f32 v38, |v4|, |v5|, |v8|
    v_max3_f32 v39, |v9|, |v12|, |v13|
    v_max_u32 v38, v38, v39
    s_nop 1
    v_max_u32_dpp v38, v38, v38 quad_perm:[1,0,3,2] row_mask:0xf bank_mask:0xf
    s_nop 1
    v_max_u32_dpp v38, v38, v38 quad_perm:[2,3,0,1] row_mask:0xf bank_mask:0xf
    s_nop 1
    v_max_u32_dpp v38, v38, v38 row_half_mirror row_mask:0xf bank_mask:0xf
    s_nop 1
    v_max_u32_dpp v38, v38, v38 row_mirror row_mask:0xf bank_mask:0xf
    s_nop 0
    v_readlane_b32 s4, v38, 0
    v_readlane_b32 s5, v38, 16
    v_readlane_b32 s6, v38, 32
    v_readlane_b32 s7, v38, 48
    s_max_u32 s4, s4, s5
    s_max_u32 s6, s6, s7
    s_max_u32 s4, s4, s6
    s_lshr_b32 s4, s4, 23
    s_max_u32 s4, s4, 14
    s_min_u32 s4, s4, 254
    s_sub_u32 s5, 267, s4
    s_lshl_b32 s19, s5, 23
    s_sub_u32 s5, s4, 13
    s_lshl_b32 s16, s5, 23
    s_mov_b32 s28, 3
Lkgen:
    v_lshlrev_b32 v2, 16, v2
    v_lshlrev_b32 v3, 16, v3
    v_mul_f32 v38, s14, v2
    v_fma_f32 v39, s14, v2, -v38
    v_exp_f32 v38, v38
    v_fmac_f32 v39, s15, v2
    v_mul_f32 v39, 0x3f317218, v39
    v_fmac_f32 v38, v38, v39
    v_cvt_pk_bf16_f32 v38, v38, v38
    v_lshlrev_b32 v40, 16, v38
    v_mul_f32 v41, v3, v37
    v_mul_f32 v40, v40, v37
    v_mul_f32 v41, 0.15915494, v41
    v_mul_f32 v40, 0xbfb8aa3b, v40
    v_mul_f32 v4, s19, v4
    v_mul_f32_e64 v5, s19, v5
    v_mul_f32 v44, 0x41000000, v40
    v_cvt_pk_f16_f32 v90, v4, -v5
    v_mul_f32 v45, 0x41000000, v41
    v_exp_f32 v48, v40
    v_exp_f32 v44, v44
    v_fract_f32 v49, v41
    v_fract_f32 v45, v45
    v_cos_f32 v46, v49
    v_cos_f32 v42, v45
    v_sin_f32 v47, v49
    v_sin_f32 v43, v45
    v_mul_f32 v46, v46, v48
    v_mul_f32 v42, v42, v44
    v_mul_f32 v47, v47, v48
    v_mul_f32 v43, v43, v44
    v_cvt_pk_f16_f32 v54, v46, -v47
    v_cvt_pk_f16_f32 v59, v42, v43
    v_mul_f32 v48, v47, v47
    v_mul_f32 v44, v43, v43
    v_add_f32 v49, v46, v46
    v_add_f32 v45, v42, v42
    v_fma_f32 v46, v46, v46, -v48
    v_fma_f32 v42, v42, v42, -v44
    v_mul_f32 v47, v49, v47
    v_mul_f32 v43, v45, v43
    v_cvt_pk_f16_f32 v55, v46, -v47
    v_cvt_pk_f16_f32 v60, v42, v43
    v_mul_f32 v48, v47, v47
    v_mul_f32 v44, v43, v43
    v_add_f32 v49, v46, v46
    v_add_f32 v45, v42, v42
    v_fma_f32 v46, v46, v46, -v48
    v_fma_f32 v42, v42, v42, -v44
    v_mul_f32 v47, v49, v47
    v_mul_f32 v43, v45, v43
    v_cvt_pk_f16_f32 v56, v46, -v47
    v_cvt_pk_f16_f32 v62, v42, v43
    v_mul_f32 v52, 0x43800000, v40
    v_mul_f32 v44, v43, v43
    v_mul_f32 v53, 0x43800000, v41
    v_add_f32 v45, v42, v42
    v_exp_f32 v52, v52
    s_waitcnt lgkmcnt(0)
    v_fma_f32 v42, v42, v42, -v44
    v_fract_f32 v53, v53
    v_mul_f32 v43, v45, v43
    v_cos_f32 v50, v53
    v_cvt_pk_f16_f32 v66, v42, v43
    v_sin_f32 v51, v53
    v_mul_f32 v44, v43, v43
    v_mul_f32 v50, v50, v52
    v_mfma_f32_16x16x32_f16 v[16:19], v[144:147], v[112:115], v[16:19]
    v_add_f32 v45, v42, v42
    v_mul_f32 v51, v51, v52
    v_fma_f32 v42, v42, v42, -v44
    v_cvt_pk_f16_f32 v57, v50, -v51
    v_mul_f32 v43, v45, v43
    v_mul_f32 v52, v51, v51
    v_cvt_pk_f16_f32 v74, v42, v43
    v_mfma_f32_16x16x32_f16 v[20:23], v[144:147], v[128:131], v[20:23]
    v_add_f32 v53, v50, v50
    v_fma_f32 v50, v50, v50, -v52
    v_mul_f32 v51, v53, v51
    v_cvt_pk_f16_f32 v14, v50, -v51
    v_mul_f32 v52, v51, v51
    v_add_f32 v53, v50, v50
    v_fma_f32 v50, v50, v50, -v52
    v_mfma_f32_16x16x32_f16 v[24:27], v[160:163], v[112:115], v[24:27]
    v_mul_f32_e64 v51, v53, v51
    v_cvt_pk_f16_f32 v15, v50, -v51
    v_pk_mul_f16 v61, v59, v60 op_sel_hi:[1,0]
    v_pk_mul_f16 v63, v59, v62 op_sel_hi:[1,0]
    v_pk_fma_f16 v61, v59, v60, v61 op_sel:[1,1,0] op_sel_hi:[0,1,1] neg_lo:[1,0,0]
    v_pk_fma_f16 v63, v59, v62, v63 op_sel:[1,1,0] op_sel_hi:[0,1,1] neg_lo:[1,0,0]
    v_pk_mul_f16 v64, v60, v62 op_sel_hi:[1,0]
    v_mfma_f32_16x16x32_f16 v[28:31], v[160:163], v[128:131], v[28:31]
    v_pk_mul_f16 v65, v61, v62 op_sel_hi:[1,0]
    v_pk_fma_f16 v64, v60, v62, v64 op_sel:[1,1,0] op_sel_hi:[0,1,1] neg_lo:[1,0,0]
    v_pk_fma_f16 v65, v61, v62, v65 op_sel:[1,1,0] op_sel_hi:[0,1,1] neg_lo:[1,0,0]
    v_pk_mul_f16 v67, v59, v66 op_sel_hi:[1,0]
    v_pk_mul_f16 v68, v60, v66 op_sel_hi:[1,0]
    v_pk_fma_f16 v67, v59, v66, v67 op_sel:[1,1,0] op_sel_hi:[0,1,1] neg_lo:[1,0,0]
    v_pk_fma_f16 v68, v60, v66, v68 op_sel:[1,1,0] op_sel_hi:[0,1,1] neg_lo:[1,0,0]
    v_pk_mul_f16 v69, v61, v66 op_sel_hi:[1,0]
    v_mfma_f32_16x16x32_f16 v[16:19], v[148:151], v[116:119], v[16:19]
    v_pk_mul_f16 v70, v62, v66 op_sel_hi:[1,0]
    v_pk_fma_f16 v69, v61, v66, v69 op_sel:[1,1,0] op_sel_hi:[0,1,1] neg_lo:[1,0,0]
    v_pk_fma_f16 v70, v62, v66, v70 op_sel:[1,1,0] op_sel_hi:[0,1,1] neg_lo:[1,0,0]
    v_pk_mul_f16 v71, v63, v66 op_sel_hi:[1,0]
    v_pk_mul_f16 v72, v64, v66 op_sel_hi:[1,0]
    v_pk_fma_f16 v71, v63, v66, v71 op_sel:[1,1,0] op_sel_hi:[0,1,1] neg_lo:[1,0,0]
    v_pk_fma_f16 v72, v64, v66, v72 op_sel:[1,1,0] op_sel_hi:[0,1,1] neg_lo:[1,0,0]
    v_mfma_f32_16x16x32_f16 v[20:23], v[148:151], v[132:135], v[20:23]
    v_pk_mul_f16 v73, v65, v66 op_sel_hi:[1,0]
    v_pk_mul_f16 v75, v59, v74 op_sel_hi:[1,0]
    v_pk_fma_f16 v73, v65, v66, v73 op_sel:[1,1,0] op_sel_hi:[0,1,1] neg_lo:[1,0,0]
    v_pk_fma_f16 v75, v59, v74, v75 op_sel:[1,1,0] op_sel_hi:[0,1,1] neg_lo:[1,0,0]
    v_pk_mul_f16 v76, v60, v74 op_sel_hi:[1,0]
    v_pk_mul_f16 v77, v61, v74 op_sel_hi:[1,0]
    v_pk_fma_f16 v76, v60, v74, v76 op_sel:[1,1,0] op_sel_hi:[0,1,1] neg_lo:[1,0,0]
    v_mfma_f32_16x16x32_f16 v[24:27], v[164:167], v[116:119], v[24:27]
    v_pk_fma_f16 v77, v61, v74, v77 op_sel:[1,1,0] op_sel_hi:[0,1,1] neg_lo:[1,0,0]
    v_pk_mul_f16 v78, v62, v74 op_sel_hi:[1,0]
    v_pk_mul_f16 v79, v63, v74 op_sel_hi:[1,0]
    v_pk_fma_f16 v78, v62, v74, v78 op_sel:[1,1,0] op_sel_hi:[0,1,1] neg_lo:[1,0,0]
    v_pk_fma_f16 v79, v63, v74, v79 op_sel:[1,1,0] op_sel_hi:[0,1,1] neg_lo:[1,0,0]
    v_pk_mul_f16 v80, v64, v74 op_sel_hi:[1,0]
    v_pk_mul_f16 v81, v65, v74 op_sel_hi:[1,0]
    v_mfma_f32_16x16x32_f16 v[28:31], v[164:167], v[132:135], v[28:31]
    v_pk_fma_f16 v80, v64, v74, v80 op_sel:[1,1,0] op_sel_hi:[0,1,1] neg_lo:[1,0,0]
    v_pk_fma_f16 v81, v65, v74, v81 op_sel:[1,1,0] op_sel_hi:[0,1,1] neg_lo:[1,0,0]
    v_pk_mul_f16 v82, v66, v74 op_sel_hi:[1,0]
    v_pk_mul_f16 v83, v67, v74 op_sel_hi:[1,0]
    v_pk_fma_f16 v82, v66, v74, v82 op_sel:[1,1,0] op_sel_hi:[0,1,1] neg_lo:[1,0,0]
    v_pk_fma_f16 v83, v67, v74, v83 op_sel:[1,1,0] op_sel_hi:[0,1,1] neg_lo:[1,0,0]
    v_pk_mul_f16 v84, v68, v74 op_sel_hi:[1,0]
    v_pk_mul_f16 v85, v69, v74 op_sel_hi:[1,0]
    v_mfma_f32_16x16x32_f16 v[16:19], v[152:155], v[120:123], v[16:19]
    v_pk_fma_f16 v84, v68, v74, v84 op_sel:[1,1,0] op_sel_hi:[0,1,1] neg_lo:[1,0,0]
    v_pk_fma_f16 v85, v69, v74, v85 op_sel:[1,1,0] op_sel_hi:[0,1,1] neg_lo:[1,0,0]
    v_pk_mul_f16 v86, v70, v74 op_sel_hi:[1,0]
    v_pk_mul_f16 v87, v71, v74 op_sel_hi:[1,0]
    v_pk_fma_f16 v86, v70, v74, v86 op_sel:[1,1,0] op_sel_hi:[0,1,1] neg_lo:[1,0,0]
    v_pk_fma_f16 v87, v71, v74, v87 op_sel:[1,1,0] op_sel_hi:[0,1,1] neg_lo:[1,0,0]
    v_pk_mul_f16 v88, v72, v74 op_sel_hi:[1,0]
    v_mfma_f32_16x16x32_f16 v[20:23], v[152:155], v[136:139], v[20:23]
    v_pk_mul_f16 v89, v73, v74 op_sel_hi:[1,0]
    v_pk_fma_f16 v88, v72, v74, v88 op_sel:[1,1,0] op_sel_hi:[0,1,1] neg_lo:[1,0,0]
    v_pk_fma_f16 v89, v73, v74, v89 op_sel:[1,1,0] op_sel_hi:[0,1,1] neg_lo:[1,0,0]
    v_pk_mul_f16 v91, v90, v54 op_sel_hi:[1,0]
    v_pk_mul_f16 v92, v90, v55 op_sel_hi:[1,0]
    v_pk_fma_f16 v91, v90, v54, v91 op_sel:[1,1,0] op_sel_hi:[0,1,1] neg_lo:[1,0,0]
    v_pk_fma_f16 v92, v90, v55, v92 op_sel:[1,1,0] op_sel_hi:[0,1,1] neg_lo:[1,0,0]
    v_mfma_f32_16x16x32_f16 v[24:27], v[168:171], v[120:123], v[24:27]
    v_pk_mul_f16 v93, v91, v55 op_sel_hi:[1,0]
    v_pk_mul_f16 v94, v90, v56 op_sel_hi:[1,0]
    v_pk_fma_f16 v93, v91, v55, v93 op_sel:[1,1,0] op_sel_hi:[0,1,1] neg_lo:[1,0,0]
    v_pk_fma_f16 v94, v90, v56, v94 op_sel:[1,1,0] op_sel_hi:[0,1,1] neg_lo:[1,0,0]
    v_pk_mul_f16 v95, v91, v56 op_sel_hi:[1,0]
    v_pk_mul_f16 v96, v92, v56 op_sel_hi:[1,0]
    v_pk_fma_f16 v95, v91, v56, v95 op_sel:[1,1,0] op_sel_hi:[0,1,1] neg_lo:[1,0,0]
    v_mfma_f32_16x16x32_f16 v[28:31], v[168:171], v[136:139], v[28:31]
    v_pk_fma_f16 v96, v92, v56, v96 op_sel:[1,1,0] op_sel_hi:[0,1,1] neg_lo:[1,0,0]
    v_pk_mul_f16 v97, v93, v56 op_sel_hi:[1,0]
    v_pk_mul_f16 v98, v90, v57 op_sel_hi:[1,0]
    v_pk_fma_f16 v97, v93, v56, v97 op_sel:[1,1,0] op_sel_hi:[0,1,1] neg_lo:[1,0,0]
    v_pk_fma_f16 v98, v90, v57, v98 op_sel:[1,1,0] op_sel_hi:[0,1,1] neg_lo:[1,0,0]
    v_pk_mul_f16 v99, v92, v57 op_sel_hi:[1,0]
    v_pk_mul_f16 v100, v94, v57 op_sel_hi:[1,0]
    v_pk_fma_f16 v99, v92, v57, v99 op_sel:[1,1,0] op_sel_hi:[0,1,1] neg_lo:[1,0,0]
    v_mfma_f32_16x16x32_f16 v[16:19], v[156:159], v[124:127], v[16:19]
    v_pk_fma_f16 v100, v94, v57, v100 op_sel:[1,1,0] op_sel_hi:[0,1,1] neg_lo:[1,0,0]
    v_pk_mul_f16 v101, v96, v57 op_sel_hi:[1,0]
    v_pk_mul_f16 v102, v90, v14 op_sel_hi:[1,0]
    v_pk_fma_f16 v101, v96, v57, v101 op_sel:[1,1,0] op_sel_hi:[0,1,1] neg_lo:[1,0,0]
    v_pk_fma_f16 v102, v90, v14, v102 op_sel:[1,1,0] op_sel_hi:[0,1,1] neg_lo:[1,0,0]
    v_pk_mul_f16 v103, v94, v14 op_sel_hi:[1,0]
    v_pk_mul_f16 v104, v98, v14 op_sel_hi:[1,0]
    v_mfma_f32_16x16x32_f16 v[20:23], v[156:159], v[140:143], v[20:23]
    v_pk_fma_f16 v103, v94, v14, v103 op_sel:[1,1,0] op_sel_hi:[0,1,1] neg_lo:[1,0,0]
    v_pk_fma_f16 v104, v98, v14, v104 op_sel:[1,1,0] op_sel_hi:[0,1,1] neg_lo:[1,0,0]
    v_pk_mul_f16 v105, v100, v14 op_sel_hi:[1,0]
    v_pk_mul_f16 v106, v90, v15 op_sel_hi:[1,0]
    v_pk_fma_f16 v105, v100, v14, v105 op_sel:[1,1,0] op_sel_hi:[0,1,1] neg_lo:[1,0,0]
    v_pk_fma_f16 v106, v90, v15, v106 op_sel:[1,1,0] op_sel_hi:[0,1,1] neg_lo:[1,0,0]
    v_pk_mul_f16 v107, v98, v15 op_sel_hi:[1,0]
    v_mfma_f32_16x16x32_f16 v[24:27], v[172:175], v[124:127], v[24:27]
    v_pk_mul_f16 v108, v102, v15 op_sel_hi:[1,0]
    v_pk_fma_f16 v107, v98, v15, v107 op_sel:[1,1,0] op_sel_hi:[0,1,1] neg_lo:[1,0,0]
    v_pk_fma_f16 v108, v102, v15, v108 op_sel:[1,1,0] op_sel_hi:[0,1,1] neg_lo:[1,0,0]
    v_pk_mul_f16 v109, v104, v15 op_sel_hi:[1,0]
    v_pk_mul_f16 v110, v106, v15 op_sel_hi:[1,0]
    v_pk_fma_f16 v109, v104, v15, v109 op_sel:[1,1,0] op_sel_hi:[0,1,1] neg_lo:[1,0,0]
    v_pk_fma_f16 v110, v106, v15, v110 op_sel:[1,1,0] op_sel_hi:[0,1,1] neg_lo:[1,0,0]
    v_mfma_f32_16x16x32_f16 v[28:31], v[172:175], v[140:143], v[28:31]
    s_cmp_lg_u32 s28, 3
    s_cbranch_scc1 Lknz
    v_mov_b32 v16, 0
    v_mov_b32 v17, 0
    v_mov_b32 v18, 0
    v_mov_b32 v19, 0
    v_mov_b32 v20, 0
    v_mov_b32 v21, 0
    v_mov_b32 v22, 0
    v_mov_b32 v23, 0
    v_mov_b32 v24, 0
    v_mov_b32 v25, 0
    v_mov_b32 v26, 0
    v_mov_b32 v27, 0
    v_mov_b32 v28, 0
    v_mov_b32 v29, 0
    v_mov_b32 v30, 0
    v_mov_b32 v31, 0
Lknz:
    ds_write_addtid_b32 v58 offset:57344
    ds_write_addtid_b32 v59 offset:57632
    ds_write_addtid_b32 v60 offset:57920
    ds_write_addtid_b32 v61 offset:58208
    ds_write_addtid_b32 v62 offset:58496
    ds_write_addtid_b32 v63 offset:58784
    ds_write_addtid_b32 v64 offset:59072
    ds_write_addtid_b32 v65 offset:59360
    ds_write_addtid_b32 v66 offset:59648
    ds_write_addtid_b32 v67 offset:59936
    ds_write_addtid_b32 v68 offset:60224
    ds_write_addtid_b32 v69 offset:60512
    ds_write_addtid_b32 v70 offset:60800
    ds_write_addtid_b32 v71 offset:61088
    ds_write_addtid_b32 v72 offset:61376
    ds_write_addtid_b32 v73 offset:61664
    ds_read_b128 v[112:115], v36 offset:0
    ds_read_b128 v[116:119], v36 offset:64
    ds_read_b128 v[120:123], v36 offset:128
    ds_read_b128 v[124:127], v36 offset:192
    ds_write_addtid_b32 v74 offset:57344
    ds_write_addtid_b32 v75 offset:57632
    ds_write_addtid_b32 v76 offset:57920
    ds_write_addtid_b32 v77 offset:58208
    ds_write_addtid_b32 v78 offset:58496
    ds_write_addtid_b32 v79 offset:58784
    ds_write_addtid_b32 v80 offset:59072
    ds_write_addtid_b32 v81 offset:59360
    ds_write_addtid_b32 v82 offset:59648
    ds_write_addtid_b32 v83 offset:59936
    ds_write_addtid_b32 v84 offset:60224
    ds_write_addtid_b32 v85 offset:60512
    ds_write_addtid_b32 v86 offset:60800
    ds_write_addtid_b32 v87 offset:61088
    ds_write_addtid_b32 v88 offset:61376
    ds_write_addtid_b32 v89 offset:61664
    ds_read_b128 v[128:131], v36 offset:0
    ds_read_b128 v[132:135], v36 offset:64
    ds_read_b128 v[136:139], v36 offset:128
    ds_read_b128 v[140:143], v36 offset:192
    ds_write_addtid_b32 v90 offset:57344
    ds_write_addtid_b32 v91 offset:57632
    ds_write_addtid_b32 v92 offset:57920
    ds_write_addtid_b32 v93 offset:58208
    ds_write_addtid_b32 v94 offset:58496
    ds_write_addtid_b32 v95 offset:58784
    ds_write_addtid_b32 v96 offset:59072
    ds_write_addtid_b32 v97 offset:59360
    ds_write_addtid_b32 v98 offset:59648
    ds_write_addtid_b32 v99 offset:59936
    ds_write_addtid_b32 v100 offset:60224
    ds_write_addtid_b32 v101 offset:60512
    ds_write_addtid_b32 v102 offset:60800
    ds_write_addtid_b32 v103 offset:61088
    ds_write_addtid_b32 v104 offset:61376
    ds_write_addtid_b32 v105 offset:61664
    ds_read_b128 v[144:147], v36 offset:0
    ds_read_b128 v[148:151], v36 offset:64
    ds_read_b128 v[152:155], v36 offset:128
    ds_read_b128 v[156:159], v36 offset:192
    ds_write_addtid_b32 v110 offset:57632
    ds_write_addtid_b32 v106 offset:57344
    ds_write_addtid_b32 v107 offset:58496
    ds_write_addtid_b32 v108 offset:59648
    ds_write_addtid_b32 v109 offset:60800
    ds_read_b128 v[160:163], v36 offset:0
    ds_read_b128 v[164:167], v36 offset:64
    ds_read_b128 v[168:171], v36 offset:128
    ds_read_b128 v[172:175], v36 offset:192
    v_mov_b32 v2, v6
    v_mov_b32 v3, v7
    v_mov_b32 v4, v8
    v_mov_b32 v5, v9
    v_mov_b32 v6, v10
    v_mov_b32 v7, v11
    v_mov_b32 v8, v12
    v_mov_b32 v9, v13
    s_lshl_b32 s4, s3, 2
    s_add_u32 s4, s4, s28
    s_cmp_eq_u32 s4, 2
    s_cbranch_scc1 LWj
LWjr:
    s_sub_u32 s28, s28, 1
    s_cmp_lg_u32 s28, 0
    s_cbranch_scc1 Lkgen
    v_mov_b32 v15, 163200
    s_waitcnt lgkmcnt(0)
    v_mfma_f32_16x16x32_f16 v[16:19], v[144:147], v[112:115], v[16:19]
    v_mfma_f32_16x16x32_f16 v[20:23], v[144:147], v[128:131], v[20:23]
    v_mfma_f32_16x16x32_f16 v[24:27], v[160:163], v[112:115], v[24:27]
    v_mfma_f32_16x16x32_f16 v[28:31], v[160:163], v[128:131], v[28:31]
    v_mfma_f32_16x16x32_f16 v[16:19], v[148:151], v[116:119], v[16:19]
    v_mfma_f32_16x16x32_f16 v[20:23], v[148:151], v[132:135], v[20:23]
    v_mfma_f32_16x16x32_f16 v[24:27], v[164:167], v[116:119], v[24:27]
    v_mfma_f32_16x16x32_f16 v[28:31], v[164:167], v[132:135], v[28:31]
    v_mfma_f32_16x16x32_f16 v[16:19], v[152:155], v[120:123], v[16:19]
    v_mfma_f32_16x16x32_f16 v[20:23], v[152:155], v[136:139], v[20:23]
    v_mfma_f32_16x16x32_f16 v[24:27], v[168:171], v[120:123], v[24:27]
    v_mfma_f32_16x16x32_f16 v[28:31], v[168:171], v[136:139], v[28:31]
    v_mfma_f32_16x16x32_f16 v[16:19], v[156:159], v[124:127], v[16:19]
    v_mfma_f32_16x16x32_f16 v[20:23], v[156:159], v[140:143], v[20:23]
    v_mfma_f32_16x16x32_f16 v[24:27], v[172:175], v[124:127], v[24:27]
    v_mfma_f32_16x16x32_f16 v[28:31], v[172:175], v[140:143], v[28:31]
    v_add_f32 v37, v37, v37
    v_mul_f32 v37, s16, v37
    s_nop 2
    v_mul_f32 v16, v37, v16
    v_mul_f32 v17, v37, v17
    v_mul_f32 v18, v37, v18
    v_mul_f32 v19, v37, v19
    v_mul_f32 v20, v37, v20
    v_mul_f32 v21, v37, v21
    v_mul_f32 v22, v37, v22
    v_mul_f32 v23, v37, v23
    v_mul_f32 v24, v37, v24
    v_mul_f32 v25, v37, v25
    v_mul_f32 v28, v37, v28
    v_and_b32 v2, 15, v0
    v_lshrrev_b32 v3, 4, v0
    v_max_u32 v4, 1, v3
    v_sub_u32 v4, 5, v4
    v_lshlrev_b32 v5, v4, v2
    v_lshlrev_b32 v6, 8, v3
    v_lshlrev_b32 v7, 3, v3
    v_cmp_gt_u32 vcc, 2, v3
    s_nop 1
    v_cndmask_b32 v7, v6, v7, vcc
    v_add3_u32 v5, v5, v7, s33
    v_cmp_eq_u32 vcc, 3, v3
    v_mov_b32 v7, 0x80
    s_nop 0
    v_cndmask_b32 v7, 4, v7, vcc
    v_add_u32 v7, v5, v7
    v_lshlrev_b32 v4, v4, 16
    v_lshlrev_b32 v6, 6, v3
    v_lshl_add_u32 v6, v2, 1, v6
    v_add_u32 v6, s33, v6
    v_cvt_pk_bf16_f32 v32, v16, v17
    v_cvt_pk_bf16_f32 v33, v18, v19
    v_cvt_pk_bf16_f32 v34, v20, v21
    v_cvt_pk_bf16_f32 v35, v22, v23
    v_cvt_pk_bf16_f32 v36, v24, v28
    v_cvt_pk_bf16_f32 v37, v25, v25
    ds_write_b32 v5, v32
    ds_write_b32 v7, v33
    v_add_u32 v5, v5, v4
    v_add_u32 v7, v7, v4
    ds_write_b32 v5, v34
    ds_write_b32 v7, v35
    ds_write_b16 v6, v36 offset:1024
    ds_write_b16_d16_hi v6, v36 offset:1056
    ds_write_b16 v6, v37 offset:1280
    s_cmp_eq_u32 s30, 1
    s_cbranch_scc1 LSa
    s_sub_u32 s4, s3, 1
    s_cmp_lt_u32 s4, 3
    s_cbranch_scc1 LSy
    s_mov_b32 s5, 0
Lls72:
    ds_read_b32 v4, v15 offset:416
    s_add_u32 s5, s5, 1
    s_waitcnt lgkmcnt(0)
    v_readfirstlane_b32 s4, v4
    s_cmp_ge_u32 s4, 1
    s_cbranch_scc1 Llse73
    s_sleep 1
    s_cmp_lt_u32 s5, 1048576
    s_cbranch_scc1 Lls72
Llse73:
Lexp:
    s_nop 0
    v_lshl_add_u32 v6, v0, 2, s33
    v_lshl_add_u32 v7, v0, 3, s33
    ds_read_b64 v[32:33], v7
    ds_read_b32 v34, v7 offset:8
    ds_read2_b32 v[36:37], v6 offset0:128 offset1:129
    ds_read2_b32 v[38:39], v6 offset0:192 offset1:193
    v_add_u32 v5, 1024, v6
    ds_read2_b32 v[40:41], v5 offset0:0 offset1:1
    s_mov_b32 s8, 0x01000100
    s_mov_b32 s9, 0x03020302
    v_lshl_add_u32 v8, v0, 4, s33
    v_lshl_add_u32 v9, v0, 5, s33
    v_mov_b32 v60, 0
    v_mov_b32 v61, 0
    v_mov_b32 v62, 0
    v_mov_b32 v63, 0
    v_mov_b32 v5, 12736
    v_mov_b32 v4, 4128
    v_cmp_gt_u32 vcc, 4, v0
    s_nop 1
    v_cndmask_b32 v5, v5, v4, vcc
    v_cmp_gt_u32 vcc, 2, v0
    s_nop 1
    v_cndmask_b32 v5, v5, 0, vcc
    v_add_u32 v5, v5, v8
    s_waitcnt lgkmcnt(0)
    v_readfirstlane_b32 s4, v32
    s_lshl_b32 s4, s4, 16
    s_nop 2
    v_writelane_b32 v63, s4, 3
    s_mov_b32 exec_hi, 3
    ds_write_b128 v5, v[60:63]
    s_mov_b64 exec, -1
    ds_write_b64 v7, v[32:33] offset:32
    v_alignbit_b32 v42, v33, v32, 16
    v_alignbit_b32 v43, v34, v33, 16
    ds_write_b64 v7, v[42:43] offset:4192
    v_perm_b32 v64, v36, v36, s8
    v_alignbit_b32 v65, v37, v36, 16
    ds_write_b64 v7, v[64:65] offset:544
    v_mov_b32_e64 v66, v36
    v_perm_b32 v67, v37, v37, s8
    ds_write_b64 v7, v[66:67] offset:4704
    v_perm_b32 v68, v38, v38, s8
    v_mov_b32_e64 v69, v38
    v_perm_b32 v70, v38, v38, s9
    v_perm_b32 v71, v39, v39, s8
    ds_write_b128 v8, v[68:71] offset:1056
    v_mov_b32 v72, v68
    v_mov_b32 v73, v70
    v_alignbit_b32 v74, v39, v38, 16
    v_mov_b32_e64 v75, v71
    ds_write_b128 v8, v[72:75] offset:5216
    v_perm_b32 v76, v40, v40, s8
    v_mov_b32 v77, v76
    v_mov_b32 v78, v40
    v_perm_b32 v79, v40, v40, s9
    v_mov_b32 v80, v79
    v_mov_b32 v81, v79
    v_perm_b32 v82, v41, v41, s8
    v_mov_b32_e64 v83, v82
    ds_write_b128 v9, v[76:79] offset:2080
    ds_write_b128 v9, v[80:83] offset:2096
    v_mov_b32 v84, v76
    v_mov_b32 v85, v76
    v_mov_b32 v86, v79
    v_mov_b32 v87, v79
    v_mov_b32 v88, v79
    v_alignbit_b32 v89, v41, v40, 16
    v_mov_b32 v90, v82
    v_mov_b32_e64 v91, v82
    ds_write_b128 v9, v[84:87] offset:6240
    ds_write_b128 v9, v[88:91] offset:6256
    v_mov_b32 v4, 1
    s_mov_b64 exec, 1
    ds_add_u32 v15, v4 offset:464
    s_mov_b64 exec, -1
    s_setprio 0
    s_cmp_lt_u32 s67, 24
    s_cbranch_scc1 Lcoop
    s_cmp_eq_u32 s3, 0
    s_cbranch_scc1 LS0
LSconv:
    s_mov_b32 s18, 4
    s_mov_b32 s30, s33
    s_mov_b32 s5, 0
Lzs80:
    ds_read_b32 v252, v15 offset:352
    s_add_u32 s5, s5, 1
    s_waitcnt lgkmcnt(0)
    v_cmp_eq_u32 vcc, 0, v252
    s_cbranch_vccnz Lzse81
    s_sleep 1
    s_cmp_lt_u32 s5, 1048576
    s_cbranch_scc1 Lzs80
Lzse81:
    s_branch LSu
Lcoop:
    s_lshr_b32 s4, s67, 1
    s_lshl_b32 s4, s4, 3
    s_and_b32 s5, s67, 1
    s_lshl_b32 s5, s5, 1
    s_add_u32 s4, s4, s5
    s_add_u32 s4, s4, 4
    s_lshl_b32 s5, s67, 1
    s_add_u32 s5, s5, 32
    s_cmp_lt_u32 s67, 16
    s_cselect_b32 s4, s4, s5
    s_mul_i32 s34, s66, 80
    s_add_u32 s34, s34, s4
    s_lshl_b32 s4, s34, 1
    s_load_dword s17, s[48:49], s4
    s_bfe_u32 s29, s3, 0x10001
    s_add_u32 s34, s34, s29
    s_mul_i32 s33, s29, 0xffffa000
    s_add_u32 s33, s33, 147456
    s_and_b32 s35, s3, 1
    s_lshl_b32 s30, s35, 8
    s_add_u32 s30, s30, s33
    s_mov_b32 s18, 2
    v_mov_b32 v15, 163200
    v_and_b32 v2, 15, v0
    v_lshrrev_b32 v3, 4, v0
LSu:
    s_lshl_b32 s6, s34, 12
    v_lshl_add_u32 v4, v3, 3, v2
    v_lshl_add_u32 v4, v4, 1, s30
    v_and_b32 v5, 1, v0
    v_cmp_eq_u32 vcc, 1, v5
    v_mov_b32 v5, 4160
    s_nop 0
    v_cndmask_b32 v5, v5, 2, vcc
    v_add_u32 v10, v4, v5
    v_add_u32 v11, 1024, v10
    v_add_u32 v12, 2048, v10
    v_add_u32 v13, 3072, v10
    v_lshlrev_b32 v4, 4, v3
    v_lshlrev_b32 v5, 5, v2
    v_sub_u32 v4, v4, v5
    s_add_u32 s4, s30, 9184
    v_add_u32 v14, s4, v4
    s_lshl_b32 s4, s3, 2
    s_add_u32 s4, s4, 163200
    v_mov_b32 v9, s4
    v_mov_b32 v16, 0
    v_mov_b32 v17, 0
    v_mov_b32 v18, 0
    v_mov_b32 v19, 0
    v_mov_b32 v20, 0
    v_mov_b32 v21, 0
    v_mov_b32 v22, 0
    v_mov_b32 v23, 0
    v_mov_b32 v24, 0
    v_mov_b32 v25, 0
    v_mov_b32 v26, 0
    v_mov_b32 v27, 0
    v_mov_b32 v28, 0
    v_mov_b32 v29, 0
    v_mov_b32 v30, 0
    v_mov_b32 v31, 0
    v_mov_b32 v32, 0
    v_mov_b32 v33, 0
    v_mov_b32 v34, 0
    v_mov_b32 v35, 0
    v_mov_b32 v36, 0
    v_mov_b32 v37, 0
    v_mov_b32 v38, 0
    v_mov_b32 v39, 0
    v_mov_b32 v40, 0
    v_mov_b32 v41, 0
    v_mov_b32 v42, 0
    v_mov_b32 v43, 0
    v_mov_b32 v44, 0
    v_mov_b32 v45, 0
    v_mov_b32 v46, 0
    v_mov_b32 v47, 0
    s_cmp_ge_u32 s67, 24
    s_cbranch_scc1 LSgo
    s_mov_b32 s5, 0
Lls82:
    ds_read_b32 v4, v15 offset:464
    s_add_u32 s5, s5, 1
    s_waitcnt lgkmcnt(0)
    v_readfirstlane_b32 s4, v4
    s_cmp_ge_u32 s4, 2
    s_cbranch_scc1 Llse83
    s_sleep 1
    s_cmp_lt_u32 s5, 1048576
    s_cbranch_scc1 Lls82
Llse83:
    s_bitcmp1_b32 s34, 0
    s_cselect_b32 s4, 0, 16
    s_lshl_b32 s17, s17, s4
    s_nop 0
    s_and_b32 s17, s17, 0xffff0000
LSgo:
    ds_read2_b32 v[48:49], v10 offset0:0 offset1:1
    ds_read2_b32 v[50:51], v10 offset0:2 offset1:3
    ds_read_b128 v[80:83], v14 offset:3584
    ds_read2_b32 v[52:53], v10 offset0:128 offset1:129
    ds_read2_b32 v[54:55], v10 offset0:130 offset1:131
    ds_read_b128 v[84:87], v14 offset:3072
    ds_read2_b32 v[56:57], v11 offset0:0 offset1:1
    ds_read2_b32 v[58:59], v11 offset0:2 offset1:3
    ds_read_b128 v[88:91], v14 offset:2560
    ds_read2_b32 v[60:61], v11 offset0:128 offset1:129
    ds_read2_b32 v[62:63], v11 offset0:130 offset1:131
    ds_read_b128 v[92:95], v14 offset:2048
    ds_read2_b32 v[64:65], v12 offset0:0 offset1:1
    ds_read2_b32 v[66:67], v12 offset0:2 offset1:3
    ds_read_b128 v[96:99], v14 offset:1536
    ds_read2_b32 v[68:69], v12 offset0:128 offset1:129
    ds_read2_b32 v[70:71], v12 offset0:130 offset1:131
    ds_read_b128 v[100:103], v14 offset:1024
    ds_read2_b32 v[72:73], v13 offset0:0 offset1:1
    ds_read2_b32 v[74:75], v13 offset0:2 offset1:3
    ds_read_b128 v[104:107], v14 offset:512
    ds_read2_b32 v[76:77], v13 offset0:128 offset1:129
    ds_read2_b32 v[78:79], v13 offset0:130 offset1:131
    ds_read_b128 v[108:111], v14 offset:0
    s_cmp_ge_u32 s67, 24
    s_cbranch_scc1 LSgo2
    s_mov_b32 s5, 0
Lzs84:
    ds_read_b32 v4, v9 offset:304
    s_add_u32 s5, s5, 1
    s_waitcnt lgkmcnt(0)
    v_cmp_eq_u32 vcc, 0, v4
    s_cbranch_vccnz Lzse85
    s_sleep 0
    s_cmp_lt_u32 s5, 1048576
    s_cbranch_scc1 Lzs84
Lzse85:
LSgo2:
    s_setprio 3
Lconv:
    s_waitcnt lgkmcnt(0)
    s_nop 0
    v_mfma_f32_16x16x32_bf16 v[44:47], v[48:51], v[108:111], v[44:47]
    ds_read2_b32 v[112:113], v10 offset0:16 offset1:17
    v_mfma_f32_16x16x32_bf16 v[40:43], v[48:51], v[104:107], v[40:43]
    ds_read2_b32 v[114:115], v10 offset0:18 offset1:19
    v_mfma_f32_16x16x32_bf16 v[36:39], v[48:51], v[100:103], v[36:39]
    ds_read_b128 v[144:147], v14 offset:3648
    v_mfma_f32_16x16x32_bf16 v[32:35], v[48:51], v[96:99], v[32:35]
    ds_read2_b32 v[116:117], v10 offset0:144 offset1:145
    v_mfma_f32_16x16x32_bf16 v[28:31], v[48:51], v[92:95], v[28:31]
    ds_read2_b32 v[118:119], v10 offset0:146 offset1:147
    v_mfma_f32_16x16x32_bf16 v[24:27], v[48:51], v[88:91], v[24:27]
    ds_read_b128 v[148:151], v14 offset:3136
    v_mfma_f32_16x16x32_bf16 v[20:23], v[48:51], v[84:87], v[20:23]
    ds_read2_b32 v[120:121], v11 offset0:16 offset1:17
    v_mfma_f32_16x16x32_bf16 v[16:19], v[48:51], v[80:83], v[16:19]
    ds_read2_b32 v[122:123], v11 offset0:18 offset1:19
    v_mfma_f32_16x16x32_bf16 v[20:23], v[52:55], v[80:83], v[20:23]
    ds_read_b128 v[152:155], v14 offset:2624
    v_mfma_f32_16x16x32_bf16 v[24:27], v[52:55], v[84:87], v[24:27]
    ds_read2_b32 v[124:125], v11 offset0:144 offset1:145
    v_mfma_f32_16x16x32_bf16 v[28:31], v[52:55], v[88:91], v[28:31]
    ds_read2_b32 v[126:127], v11 offset0:146 offset1:147
    v_mfma_f32_16x16x32_bf16 v[32:35], v[52:55], v[92:95], v[32:35]
    ds_read_b128 v[156:159], v14 offset:2112
    v_mfma_f32_16x16x32_bf16 v[36:39], v[52:55], v[96:99], v[36:39]
    ds_read2_b32 v[128:129], v12 offset0:16 offset1:17
    v_mfma_f32_16x16x32_bf16 v[40:43], v[52:55], v[100:103], v[40:43]
    ds_read2_b32 v[130:131], v12 offset0:18 offset1:19
    v_mfma_f32_16x16x32_bf16 v[44:47], v[52:55], v[104:107], v[44:47]
    ds_read_b128 v[160:163], v14 offset:1600
    v_mfma_f32_16x16x32_bf16 v[44:47], v[56:59], v[100:103], v[44:47]
    ds_read2_b32 v[132:133], v12 offset0:144 offset1:145
    v_mfma_f32_16x16x32_bf16 v[40:43], v[56:59], v[96:99], v[40:43]
    ds_read2_b32 v[134:135], v12 offset0:146 offset1:147
    v_mfma_f32_16x16x32_bf16 v[36:39], v[56:59], v[92:95], v[36:39]
    ds_read_b128 v[164:167], v14 offset:1088
    v_mfma_f32_16x16x32_bf16 v[32:35], v[56:59], v[88:91], v[32:35]
    ds_read2_b32 v[136:137], v13 offset0:16 offset1:17
    v_mfma_f32_16x16x32_bf16 v[28:31], v[56:59], v[84:87], v[28:31]
    ds_read2_b32 v[138:139], v13 offset0:18 offset1:19
    v_mfma_f32_16x16x32_bf16 v[24:27], v[56:59], v[80:83], v[24:27]
    ds_read_b128 v[168:171], v14 offset:576
    v_mfma_f32_16x16x32_bf16 v[28:31], v[60:63], v[80:83], v[28:31]
    ds_read2_b32 v[140:141], v13 offset0:144 offset1:145
    v_mfma_f32_16x16x32_bf16 v[32:35], v[60:63], v[84:87], v[32:35]
    ds_read2_b32 v[142:143], v13 offset0:146 offset1:147
    v_mfma_f32_16x16x32_bf16 v[36:39], v[60:63], v[88:91], v[36:39]
    ds_read_b128 v[172:175], v14 offset:64
    v_mfma_f32_16x16x32_bf16 v[40:43], v[60:63], v[92:95], v[40:43]
    v_mfma_f32_16x16x32_bf16 v[44:47], v[60:63], v[96:99], v[44:47]
    v_mfma_f32_16x16x32_bf16 v[44:47], v[64:67], v[92:95], v[44:47]
    v_mfma_f32_16x16x32_bf16 v[40:43], v[64:67], v[88:91], v[40:43]
    v_mfma_f32_16x16x32_bf16 v[36:39], v[64:67], v[84:87], v[36:39]
    v_mfma_f32_16x16x32_bf16 v[32:35], v[64:67], v[80:83], v[32:35]
    v_mfma_f32_16x16x32_bf16 v[36:39], v[68:71], v[80:83], v[36:39]
    v_mfma_f32_16x16x32_bf16 v[40:43], v[68:71], v[84:87], v[40:43]
    v_mfma_f32_16x16x32_bf16 v[44:47], v[68:71], v[88:91], v[44:47]
    v_mfma_f32_16x16x32_bf16 v[44:47], v[72:75], v[84:87], v[44:47]
    v_mfma_f32_16x16x32_bf16 v[40:43], v[72:75], v[80:83], v[40:43]
    v_mfma_f32_16x16x32_bf16 v[44:47], v[76:79], v[80:83], v[44:47]
    s_waitcnt lgkmcnt(0)
    s_nop 0
    v_mfma_f32_16x16x32_bf16 v[44:47], v[112:115], v[172:175], v[44:47]
    ds_read2_b32 v[48:49], v10 offset0:32 offset1:33
    v_mfma_f32_16x16x32_bf16 v[40:43], v[112:115], v[168:171], v[40:43]
    ds_read2_b32 v[50:51], v10 offset0:34 offset1:35
    v_mfma_f32_16x16x32_bf16 v[36:39], v[112:115], v[164:167], v[36:39]
    ds_read_b128 v[80:83], v14 offset:3712
    v_mfma_f32_16x16x32_bf16 v[32:35], v[112:115], v[160:163], v[32:35]
    ds_read2_b32 v[52:53], v10 offset0:160 offset1:161
    v_mfma_f32_16x16x32_bf16 v[28:31], v[112:115], v[156:159], v[28:31]
    ds_read2_b32 v[54:55], v10 offset0:162 offset1:163
    v_mfma_f32_16x16x32_bf16 v[24:27], v[112:115], v[152:155], v[24:27]
    ds_read_b128 v[84:87], v14 offset:3200
    v_mfma_f32_16x16x32_bf16 v[20:23], v[112:115], v[148:151], v[20:23]
    ds_read2_b32 v[56:57], v11 offset0:32 offset1:33
    v_mfma_f32_16x16x32_bf16 v[16:19], v[112:115], v[144:147], v[16:19]
    ds_read2_b32 v[58:59], v11 offset0:34 offset1:35
    v_mfma_f32_16x16x32_bf16 v[20:23], v[116:119], v[144:147], v[20:23]
    ds_read_b128 v[88:91], v14 offset:2688
    v_mfma_f32_16x16x32_bf16 v[24:27], v[116:119], v[148:151], v[24:27]
    ds_read2_b32 v[60:61], v11 offset0:160 offset1:161
    v_mfma_f32_16x16x32_bf16 v[28:31], v[116:119], v[152:155], v[28:31]
    ds_read2_b32 v[62:63], v11 offset0:162 offset1:163
    v_mfma_f32_16x16x32_bf16 v[32:35], v[116:119], v[156:159], v[32:35]
    ds_read_b128 v[92:95], v14 offset:2176
    v_mfma_f32_16x16x32_bf16 v[36:39], v[116:119], v[160:163], v[36:39]
    ds_read2_b32 v[64:65], v12 offset0:32 offset1:33
    v_mfma_f32_16x16x32_bf16 v[40:43], v[116:119], v[164:167], v[40:43]
    ds_read2_b32 v[66:67], v12 offset0:34 offset1:35
    v_mfma_f32_16x16x32_bf16 v[44:47], v[116:119], v[168:171], v[44:47]
    ds_read_b128 v[96:99], v14 offset:1664
    v_mfma_f32_16x16x32_bf16 v[44:47], v[120:123], v[164:167], v[44:47]
    ds_read2_b32 v[68:69], v12 offset0:160 offset1:161
    v_mfma_f32_16x16x32_bf16 v[40:43], v[120:123], v[160:163], v[40:43]
    ds_read2_b32 v[70:71], v12 offset0:162 offset1:163
    v_mfma_f32_16x16x32_bf16 v[36:39], v[120:123], v[156:159], v[36:39]
    ds_read_b128 v[100:103], v14 offset:1152
    v_mfma_f32_16x16x32_bf16 v[32:35], v[120:123], v[152:155], v[32:35]
    ds_read2_b32 v[72:73], v13 offset0:32 offset1:33
    v_mfma_f32_16x16x32_bf16 v[28:31], v[120:123], v[148:151], v[28:31]
    ds_read2_b32 v[74:75], v13 offset0:34 offset1:35
    v_mfma_f32_16x16x32_bf16 v[24:27], v[120:123], v[144:147], v[24:27]
    ds_read_b128 v[104:107], v14 offset:640
    v_mfma_f32_16x16x32_bf16 v[28:31], v[124:127], v[144:147], v[28:31]
    ds_read2_b32 v[76:77], v13 offset0:160 offset1:161
    v_mfma_f32_16x16x32_bf16 v[32:35], v[124:127], v[148:151], v[32:35]
    ds_read2_b32 v[78:79], v13 offset0:162 offset1:163
    v_mfma_f32_16x16x32_bf16 v[36:39], v[124:127], v[152:155], v[36:39]
    ds_read_b128 v[108:111], v14 offset:128
    v_mfma_f32_16x16x32_bf16 v[40:43], v[124:127], v[156:159], v[40:43]
    v_add_u32 v10, 128, v10
    v_mfma_f32_16x16x32_bf16 v[44:47], v[124:127], v[160:163], v[44:47]
    v_add_u32 v11, 128, v11
    v_mfma_f32_16x16x32_bf16 v[44:47], v[128:131], v[156:159], v[44:47]
    v_add_u32 v12, 128, v12
    v_mfma_f32_16x16x32_bf16 v[40:43], v[128:131], v[152:155], v[40:43]
    v_add_u32 v13, 128, v13
    v_mfma_f32_16x16x32_bf16 v[36:39], v[128:131], v[148:151], v[36:39]
    v_add_u32 v14, 128, v14
    v_mfma_f32_16x16x32_bf16 v[32:35], v[128:131], v[144:147], v[32:35]
    s_sub_u32 s18, s18, 1
    v_mfma_f32_16x16x32_bf16 v[36:39], v[132:135], v[144:147], v[36:39]
    s_cmp_lg_u32 s18, 0
    v_mfma_f32_16x16x32_bf16 v[40:43], v[132:135], v[148:151], v[40:43]
    v_mfma_f32_16x16x32_bf16 v[44:47], v[132:135], v[152:155], v[44:47]
    v_mfma_f32_16x16x32_bf16 v[44:47], v[136:139], v[148:151], v[44:47]
    v_mfma_f32_16x16x32_bf16 v[40:43], v[136:139], v[144:147], v[40:43]
    v_mfma_f32_16x16x32_bf16 v[44:47], v[140:143], v[144:147], v[44:47]
    s_cbranch_scc1 Lconv
    s_setprio 3
    v_lshlrev_b32_e64 v4, 5, v2
    v_lshl_add_u32 v4, v3, 3, v4
    s_add_u32 s4, s33, 9208
    v_sub_u32 v5, s4, v4
    s_waitcnt lgkmcnt(0)
    v_and_b32 v6, 1, v3
    v_lshlrev_b32 v6, 9, v6
    v_lshl_add_u32 v6, v2, 5, v6
    v_lshrrev_b32_e64 v7, 1, v3
    v_lshl_add_u32 v6, v7, 4, v6
    s_add_u32 s7, s6, 131072
    s_cmp_lt_u32 s67, 24
    s_cbranch_scc1 LCx
    ds_read_b64 v[48:49], v5 offset:3584
    ds_read_b64 v[50:51], v5 offset:3072
    ds_read_b64 v[52:53], v5 offset:2560
    ds_read_b64 v[54:55], v5 offset:2048
    ds_read_b64 v[56:57], v5 offset:1536
    ds_read_b64 v[58:59], v5 offset:1024
    ds_read_b64 v[60:61], v5 offset:512
    ds_read_b64 v[62:63], v5 offset:0
    s_waitcnt lgkmcnt(7)
    v_and_b32 v80, 0xffff0000, v49
    v_lshlrev_b32 v81, 16, v49
    v_and_b32 v82, 0xffff0000, v48
    v_lshlrev_b32 v83, 16, v48
    v_fmac_f32 v16, s17, v80
    v_fmac_f32 v17, s17, v81
    v_fmac_f32 v18, s17, v82
    v_fmac_f32_e64 v19, s17, v83
    v_cvt_pk_bf16_f32 v64, v16, v17
    v_cvt_pk_bf16_f32 v65, v18, v19
    s_waitcnt lgkmcnt(6)
    v_and_b32 v80, 0xffff0000, v51
    v_lshlrev_b32 v81, 16, v51
    v_and_b32 v82, 0xffff0000, v50
    v_lshlrev_b32 v83, 16, v50
    v_fmac_f32 v20, s17, v80
    v_fmac_f32 v21, s17, v81
    v_fmac_f32 v22, s17, v82
    v_fmac_f32_e64 v23, s17, v83
    v_cvt_pk_bf16_f32 v66, v20, v21
    v_cvt_pk_bf16_f32 v67, v22, v23
    s_nop 0
    v_permlane16_swap_b32 v64, v66
    v_permlane16_swap_b32 v65, v67
    buffer_store_dwordx4 v[64:67], v6, s[20:23], s7 offen offset:0 sc1
    s_waitcnt lgkmcnt(5)
    v_and_b32 v80, 0xffff0000, v53
    v_lshlrev_b32 v81, 16, v53
    v_and_b32 v82, 0xffff0000, v52
    v_lshlrev_b32 v83, 16, v52
    v_fmac_f32 v24, s17, v80
    v_fmac_f32 v25, s17, v81
    v_fmac_f32 v26, s17, v82
    v_fmac_f32 v27, s17, v83
    v_cvt_pk_bf16_f32 v68, v24, v25
    v_cvt_pk_bf16_f32 v69, v26, v27
    s_waitcnt lgkmcnt(4)
    v_and_b32 v80, 0xffff0000, v55
    v_lshlrev_b32 v81, 16, v55
    v_and_b32 v82, 0xffff0000, v54
    v_lshlrev_b32 v83, 16, v54
    v_fmac_f32 v28, s17, v80
    v_fmac_f32 v29, s17, v81
    v_fmac_f32 v30, s17, v82
    v_fmac_f32_e64 v31, s17, v83
    v_cvt_pk_bf16_f32 v70, v28, v29
    v_cvt_pk_bf16_f32 v71, v30, v31
    s_nop 0
    v_permlane16_swap_b32 v68, v70
    v_permlane16_swap_b32 v69, v71
    buffer_store_dwordx4 v[68:71], v6, s[20:23], s7 offen offset:1024 sc1
    s_waitcnt lgkmcnt(3)
    v_and_b32 v80, 0xffff0000, v57
    v_lshlrev_b32 v81, 16, v57
    v_and_b32 v82, 0xffff0000, v56
    v_lshlrev_b32 v83, 16, v56
    v_fmac_f32 v32, s17, v80
    v_fmac_f32 v33, s17, v81
    v_fmac_f32 v34, s17, v82
    v_fmac_f32 v35, s17, v83
    v_cvt_pk_bf16_f32 v72, v32, v33
    v_cvt_pk_bf16_f32 v73, v34, v35
    s_waitcnt lgkmcnt(2)
    v_and_b32 v80, 0xffff0000, v59
    v_lshlrev_b32 v81, 16, v59
    v_and_b32 v82, 0xffff0000, v58
    v_lshlrev_b32 v83, 16, v58
    v_fmac_f32 v36, s17, v80
    v_fmac_f32 v37, s17, v81
    v_fmac_f32 v38, s17, v82
    v_fmac_f32_e64 v39, s17, v83
    v_cvt_pk_bf16_f32 v74, v36, v37
    v_cvt_pk_bf16_f32 v75, v38, v39
    s_nop 0
    v_permlane16_swap_b32 v72, v74
    v_permlane16_swap_b32 v73, v75
    buffer_store_dwordx4 v[72:75], v6, s[20:23], s7 offen offset:2048 sc1
    s_waitcnt lgkmcnt(1)
    v_and_b32 v80, 0xffff0000, v61
    v_lshlrev_b32 v81, 16, v61
    v_and_b32 v82, 0xffff0000, v60
    v_lshlrev_b32 v83, 16, v60
    v_fmac_f32 v40, s17, v80
    v_fmac_f32 v41, s17, v81
    v_fmac_f32 v42, s17, v82
    v_fmac_f32 v43, s17, v83
    v_cvt_pk_bf16_f32 v76, v40, v41
    v_cvt_pk_bf16_f32 v77, v42, v43
    s_waitcnt lgkmcnt(0)
    v_and_b32 v80, 0xffff0000, v63
    v_lshlrev_b32 v81, 16, v63
    v_and_b32 v82, 0xffff0000, v62
    v_lshlrev_b32 v83, 16, v62
    v_fmac_f32 v44, s17, v80
    v_fmac_f32 v45, s17, v81
    v_fmac_f32 v46, s17, v82
    v_fmac_f32_e64 v47, s17, v83
    v_cvt_pk_bf16_f32 v78, v44, v45
    v_cvt_pk_bf16_f32 v79, v46, v47
    s_nop 0
    v_permlane16_swap_b32 v76, v78
    v_permlane16_swap_b32 v77, v79
    buffer_store_dwordx4 v[76:79], v6, s[20:23], s7 offen offset:3072 sc1
    v_mov_b32 v5, 1
    s_mov_b64 exec, 1
    ds_write_b32 v9, v5 offset:372
    s_mov_b64 exec, -1
    s_cmp_eq_u32 s3, 4
    s_cbranch_scc1 LPlast
    s_waitcnt vmcnt(0)
LPlastr:
    s_add_u32 s6, s66, 128
    s_mov_b32 s5, 0
Lls90:
    ds_read_b32 v252, v15 offset:404
    s_add_u32 s5, s5, 1
    s_waitcnt lgkmcnt(0)
    v_readfirstlane_b32 s4, v252
    s_cmp_ge_u32 s4, 1
    s_cbranch_scc1 Llse91
    s_sleep 4
    s_cmp_lt_u32 s5, 1048576
    s_cbranch_scc1 Lls90
Llse91:
LCsig:
    s_lshl_b32 s4, s6, 7
    v_mov_b32 v252, s4
    v_mov_b32 v253, 1
    s_mov_b64 exec, 1
    buffer_atomic_add v253, v252, s[20:23], 0 offen sc0 sc1
    s_mov_b64 exec, -1
    s_lshl_b32 s4, s66, 3
    s_add_u32 s4, s4, 198
    v_add_u32 v252, s4, v0
    v_lshlrev_b32 v252, 7, v252
    v_mov_b32 v254, 1
    s_waitcnt vmcnt(0)
    v_readfirstlane_b32 s4, v253
    s_cmp_lg_u32 s4, 79
    s_cbranch_scc1 Lsl92
    s_mov_b64 exec, 255
    buffer_store_dword v254, v252, s[20:23], 0 offen sc1
    s_mov_b64 exec, -1
Lsl92:
LCdone:
    s_lshr_b32 s4, s2, 6
    s_lshl_b32 s4, s4, 3
    s_add_u32 s4, s4, s3
    s_cmp_eq_u32 s4, 28
    s_cbranch_scc1 LPret
    s_cmp_eq_u32 s4, 31
    s_cbranch_scc1 LCend
    s_cmp_eq_u32 s3, 7
    s_cbranch_scc1 LJret
LCend:
    s_endpgm
LS0:
    v_mov_b32 v4, 0
    s_mov_b64 exec, 1
    ds_write_b32 v15, v4 offset:320
    s_mov_b64 exec, -1
LS2G:
    s_setprio 2
    v_mov_b32 v13, 163200
    v_lshlrev_b32 v5, 4, v0
    s_lshr_b32 s6, s66, 1
    s_lshl_b32 s6, s6, 3
    s_and_b32 s7, s67, 7
    s_add_u32 s31, s6, s7
    s_and_b32 s6, s66, 1
    s_lshl_b32 s6, s6, 2
    s_lshr_b32 s7, s67, 3
    s_add_u32 s32, s6, s7
    s_mul_i32 s18, s32, 245760
    s_mul_i32 s7, s3, 61440
    s_add_u32 s18, s18, s7
    s_add_u32 s18, s18, 5373952
    s_mov_b32 s5, 0
Lls93:
    ds_read_b32 v16, v13 offset:404
    s_add_u32 s5, s5, 1
    s_waitcnt lgkmcnt(0)
    v_readfirstlane_b32 s4, v16
    s_cmp_ge_u32 s4, 1
    s_cbranch_scc1 Llse94
    s_sleep 4
    s_cmp_lt_u32 s5, 1048576
    s_cbranch_scc1 Lls93
Llse94:
    s_mov_b32 s5, 0
Lls95:
    ds_read_b32 v16, v13 offset:408
    s_add_u32 s5, s5, 1
    s_waitcnt lgkmcnt(0)
    v_readfirstlane_b32 s4, v16
    s_cmp_ge_u32 s4, 3
    s_cbranch_scc1 Llse96
    s_sleep 4
    s_cmp_lt_u32 s5, 1048576
    s_cbranch_scc1 Lls95
Llse96:
    buffer_load_dwordx4 v[20:23], v5, s[20:23], s18 offen offset:0 sc1
    buffer_load_dwordx4 v[24:27], v5, s[20:23], s18 offen offset:1024 sc1
    buffer_load_dwordx4 v[28:31], v5, s[20:23], s18 offen offset:2048 sc1
    buffer_load_dwordx4 v[32:35], v5, s[20:23], s18 offen offset:3072 sc1
    s_add_u32 s18, s18, 4096
    buffer_load_dwordx4 v[36:39], v5, s[20:23], s18 offen offset:0 sc1
    buffer_load_dwordx4 v[40:43], v5, s[20:23], s18 offen offset:1024 sc1
    buffer_load_dwordx4 v[44:47], v5, s[20:23], s18 offen offset:2048 sc1
    buffer_load_dwordx4 v[48:51], v5, s[20:23], s18 offen offset:3072 sc1
    s_add_u32 s18, s18, 4096
    buffer_load_dwordx4 v[52:55], v5, s[20:23], s18 offen offset:0 sc1
    buffer_load_dwordx4 v[56:59], v5, s[20:23], s18 offen offset:1024 sc1
    buffer_load_dwordx4 v[60:63], v5, s[20:23], s18 offen offset:2048 sc1
    buffer_load_dwordx4 v[64:67], v5, s[20:23], s18 offen offset:3072 sc1
    s_add_u32 s18, s18, 4096
    buffer_load_dwordx4 v[68:71], v5, s[20:23], s18 offen offset:0 sc1
    buffer_load_dwordx4 v[72:75], v5, s[20:23], s18 offen offset:1024 sc1
    buffer_load_dwordx4 v[76:79], v5, s[20:23], s18 offen offset:2048 sc1
    s_mov_b32 s5, 0
Lls97:
    ds_read_b32 v16, v13 offset:464
    s_add_u32 s5, s5, 1
    s_waitcnt lgkmcnt(0)
    v_readfirstlane_b32 s4, v16
    s_cmp_ge_u32 s4, 7
    s_cbranch_scc1 Llse98
    s_sleep 4
    s_cmp_lt_u32 s5, 1048576
    s_cbranch_scc1 Lls97
Llse98:
    s_mul_i32 s4, s3, 30720
    s_mov_b32 m0, s4
    s_nop 0
    s_add_u32 s6, s18, 18432
    buffer_load_dwordx4 v5, s[20:23], s6 offen offset:0 sc1 lds
    buffer_load_dwordx4 v5, s[20:23], s6 offen offset:1024 sc1 lds
    buffer_load_dwordx4 v5, s[20:23], s6 offen offset:2048 sc1 lds
    buffer_load_dwordx4 v5, s[20:23], s6 offen offset:3072 sc1 lds
    s_add_u32 m0, m0, 4096
    s_add_u32 s6, s6, 4096
    buffer_load_dwordx4 v5, s[20:23], s6 offen offset:0 sc1 lds
    buffer_load_dwordx4 v5, s[20:23], s6 offen offset:1024 sc1 lds
    buffer_load_dwordx4 v5, s[20:23], s6 offen offset:2048 sc1 lds
    buffer_load_dwordx4 v5, s[20:23], s6 offen offset:3072 sc1 lds
    s_add_u32 m0, m0, 4096
    s_add_u32 s6, s6, 4096
    buffer_load_dwordx4 v5, s[20:23], s6 offen offset:0 sc1 lds
    buffer_load_dwordx4 v5, s[20:23], s6 offen offset:1024 sc1 lds
    buffer_load_dwordx4 v5, s[20:23], s6 offen offset:2048 sc1 lds
    buffer_load_dwordx4 v5, s[20:23], s6 offen offset:3072 sc1 lds
    s_add_u32 m0, m0, 4096
    s_add_u32 s6, s6, 4096
    buffer_load_dwordx4 v5, s[20:23], s6 offen offset:0 sc1 lds
    buffer_load_dwordx4 v5, s[20:23], s6 offen offset:1024 sc1 lds
    buffer_load_dwordx4 v5, s[20:23], s6 offen offset:2048 sc1 lds
    buffer_load_dwordx4 v5, s[20:23], s6 offen offset:3072 sc1 lds
    s_add_u32 m0, m0, 4096
    s_add_u32 s6, s6, 4096
    s_cmp_eq_u32 s3, 0
    s_cbranch_scc1 LG2b
    buffer_load_dwordx4 v5, s[20:23], s6 offen offset:0 sc1 lds
    buffer_load_dwordx4 v5, s[20:23], s6 offen offset:1024 sc1 lds
    buffer_load_dwordx4 v5, s[20:23], s6 offen offset:2048 sc1 lds
    buffer_load_dwordx4 v5, s[20:23], s6 offen offset:3072 sc1 lds
    s_add_u32 m0, m0, 4096
    s_add_u32 s6, s6, 4096
    buffer_load_dwordx4 v5, s[20:23], s6 offen offset:0 sc1 lds
    buffer_load_dwordx4 v5, s[20:23], s6 offen offset:1024 sc1 lds
    buffer_load_dwordx4 v5, s[20:23], s6 offen offset:2048 sc1 lds
    buffer_load_dwordx4 v5, s[20:23], s6 offen offset:3072 sc1 lds
    s_add_u32 m0, m0, 4096
    s_add_u32 s6, s6, 4096
    buffer_load_dwordx4 v5, s[20:23], s6 offen offset:0 sc1 lds
    buffer_load_dwordx4 v5, s[20:23], s6 offen offset:1024 sc1 lds
    buffer_load_dwordx4 v5, s[20:23], s6 offen offset:2048 sc1 lds
    buffer_load_dwordx4 v5, s[20:23], s6 offen offset:3072 sc1 lds
    s_add_u32 m0, m0, 4096
    s_add_u32 s6, s6, 4096
    buffer_load_dwordx4 v5, s[20:23], s6 offen offset:0 sc1 lds
    buffer_load_dwordx4 v5, s[20:23], s6 offen offset:1024 sc1 lds
    s_branch LG2b
LG1w0:
    s_mov_b32 s5, 0
Lzs19:
    ds_read_b64 v[14:15], v11 offset:8
    s_add_u32 s5, s5, 1
    s_waitcnt lgkmcnt(0)
    v_or_b32 v14, v14, v15
    v_cmp_eq_u32 vcc, 0, v14
    s_cbranch_vccnz LG1r0
    s_sleep 1
    s_cmp_lt_u32 s5, 1048576
    s_cbranch_scc1 Lzs19
    s_branch LG1r0
LG1w1:
    s_mov_b32 s5, 0
Lzs20:
    ds_read_b64 v[14:15], v11 offset:16
    s_add_u32 s5, s5, 1
    s_waitcnt lgkmcnt(0)
    v_or_b32 v14, v14, v15
    v_cmp_eq_u32 vcc, 0, v14
    s_cbranch_vccnz LG1r1
    s_sleep 1
    s_cmp_lt_u32 s5, 1048576
    s_cbranch_scc1 Lzs20
    s_branch LG1r1
LG1w0L:
    s_mov_b32 s5, 0
Lzs21:
    ds_read_b64 v[14:15], v11 offset:8
    s_add_u32 s5, s5, 1
    s_waitcnt lgkmcnt(0)
    v_or_b32 v14, v14, v15
    v_cmp_eq_u32 vcc, 0, v14
    s_cbranch_vccnz LG1r0L
    s_sleep 1
    s_cmp_lt_u32 s5, 1048576
    s_cbranch_scc1 Lzs21
    s_branch LG1r0L
LG1ww:
    s_mov_b32 s5, 0
Lls22:
    ds_read_b32 v14, v13 offset:404
    s_add_u32 s5, s5, 1
    s_waitcnt lgkmcnt(0)
    v_readfirstlane_b32 s4, v14
    s_cmp_ge_u32 s4, 1
    s_cbranch_scc1 LG1wr
    s_sleep 1
    s_cmp_lt_u32 s5, 1048576
    s_cbranch_scc1 Lls22
    s_branch LG1wr
LG2w:
    s_mov_b32 s5, 0
Lzs25:
    ds_read_b64 v[16:17], v13 offset:360
    s_add_u32 s5, s5, 1
    s_waitcnt lgkmcnt(0)
    v_or_b32 v16, v16, v17
    v_cmp_eq_u32 vcc, 0, v16
    s_cbranch_vccnz LG2wr
    s_sleep 1
    s_cmp_lt_u32 s5, 1048576
    s_cbranch_scc1 Lzs25
    s_branch LG2wr
LWj:
    s_setprio 3
    v_lshrrev_b32 v248, 4, v0
    v_bfe_u32 v249, v0, 2, 2
    v_and_b32_e64 v250, 3, v0
    v_mul_u32_u24 v251, 1280, v249
    v_mul_u32_u24 v249, 160, v248
    v_add_u32_e64 v251, v251, v249
    v_add_u32 v251, 125952, v251
    v_lshl_add_u32 v249, v250, 3, v251
    v_lshl_add_u32 v251, v250, 4, v251
    v_mul_u32_u24 v248, 245760, v248
    v_and_b32_e64 v250, 15, v0
    v_lshl_add_u32 v248, v250, 4, v248
    s_sub_u32 s6, s2, 192
    s_mul_i32 s6, s6, 3
    s_waitcnt vmcnt(0)
    ds_read_b64_tr_b16 v[176:177], v251 offset:0
    ds_read_b64_tr_b16 v[178:179], v251 offset:5120
    ds_read_b64_tr_b16 v[180:181], v251 offset:8
    ds_read_b64_tr_b16 v[182:183], v251 offset:5128
    ds_read_b64_tr_b16 v[184:185], v251 offset:64
    ds_read_b64_tr_b16 v[186:187], v251 offset:5184
    ds_read_b64_tr_b16 v[188:189], v251 offset:72
    ds_read_b64_tr_b16 v[190:191], v251 offset:5192
    ds_read_b64_tr_b16 v[192:193], v249 offset:128
    ds_read_b64_tr_b16 v[194:195], v249 offset:5248
    ds_read_b64_tr_b16 v[196:197], v251 offset:640
    ds_read_b64_tr_b16 v[198:199], v251 offset:5760
    ds_read_b64_tr_b16 v[200:201], v251 offset:648
    ds_read_b64_tr_b16 v[202:203], v251 offset:5768
    ds_read_b64_tr_b16 v[204:205], v251 offset:704
    ds_read_b64_tr_b16 v[206:207], v251 offset:5824
    ds_read_b64_tr_b16 v[208:209], v251 offset:712
    ds_read_b64_tr_b16 v[210:211], v251 offset:5832
    ds_read_b64_tr_b16 v[212:213], v249 offset:768
    ds_read_b64_tr_b16 v[214:215], v249 offset:5888
    s_lshr_b32 s4, s6, 2
    s_mul_i32 s7, s4, 5120
    s_and_b32 s4, s6, 3
    s_lshl_b32 s4, s4, 8
    s_add_u32 s7, s7, s4
    s_add_u32 s6, s6, 1
    s_waitcnt lgkmcnt(0)
    s_add_u32 s4, s7, 5373952
    buffer_store_dwordx4 v[176:179], v248, s[20:23], s4 offen sc1
    s_add_u32 s4, s7, 5374976
    buffer_store_dwordx4 v[180:183], v248, s[20:23], s4 offen sc1
    s_add_u32 s4, s7, 5376000
    buffer_store_dwordx4 v[184:187], v248, s[20:23], s4 offen sc1
    s_add_u32 s4, s7, 5377024
    buffer_store_dwordx4 v[188:191], v248, s[20:23], s4 offen sc1
    s_add_u32 s4, s7, 5378048
    buffer_store_dwordx4 v[192:195], v248, s[20:23], s4 offen sc1
    s_add_u32 s4, s7, 6356992
    buffer_store_dwordx4 v[196:199], v248, s[20:23], s4 offen sc1
    s_add_u32 s4, s7, 6358016
    buffer_store_dwordx4 v[200:203], v248, s[20:23], s4 offen sc1
    s_add_u32 s4, s7, 6359040
    buffer_store_dwordx4 v[204:207], v248, s[20:23], s4 offen sc1
    s_add_u32 s4, s7, 6360064
    buffer_store_dwordx4 v[208:211], v248, s[20:23], s4 offen sc1
    s_add_u32 s4, s7, 6361088
    buffer_store_dwordx4 v[212:215], v248, s[20:23], s4 offen sc1
    ds_read_b64_tr_b16 v[176:177], v251 offset:13440
    ds_read_b64_tr_b16 v[178:179], v251 offset:18560
    ds_read_b64_tr_b16 v[180:181], v251 offset:13448
    ds_read_b64_tr_b16 v[182:183], v251 offset:18568
    ds_read_b64_tr_b16 v[184:185], v251 offset:13504
    ds_read_b64_tr_b16 v[186:187], v251 offset:18624
    ds_read_b64_tr_b16 v[188:189], v251 offset:13512
    ds_read_b64_tr_b16 v[190:191], v251 offset:18632
    ds_read_b64_tr_b16 v[192:193], v249 offset:13568
    ds_read_b64_tr_b16 v[194:195], v249 offset:18688
    ds_read_b64_tr_b16 v[196:197], v251 offset:14080
    ds_read_b64_tr_b16 v[198:199], v251 offset:19200
    ds_read_b64_tr_b16 v[200:201], v251 offset:14088
    ds_read_b64_tr_b16 v[202:203], v251 offset:19208
    ds_read_b64_tr_b16 v[204:205], v251 offset:14144
    ds_read_b64_tr_b16 v[206:207], v251 offset:19264
    ds_read_b64_tr_b16 v[208:209], v251 offset:14152
    ds_read_b64_tr_b16 v[210:211], v251 offset:19272
    ds_read_b64_tr_b16 v[212:213], v249 offset:14208
    ds_read_b64_tr_b16 v[214:215], v249 offset:19328
    s_lshr_b32 s4, s6, 2
    s_mul_i32 s7, s4, 5120
    s_and_b32 s4, s6, 3
    s_lshl_b32 s4, s4, 8
    s_add_u32 s7, s7, s4
    s_add_u32 s6, s6, 1
    s_waitcnt lgkmcnt(0)
    s_add_u32 s4, s7, 5373952
    buffer_store_dwordx4 v[176:179], v248, s[20:23], s4 offen sc1
    s_add_u32 s4, s7, 5374976
    buffer_store_dwordx4 v[180:183], v248, s[20:23], s4 offen sc1
    s_add_u32 s4, s7, 5376000
    buffer_store_dwordx4 v[184:187], v248, s[20:23], s4 offen sc1
    s_add_u32 s4, s7, 5377024
    buffer_store_dwordx4 v[188:191], v248, s[20:23], s4 offen sc1
    s_add_u32 s4, s7, 5378048
    buffer_store_dwordx4 v[192:195], v248, s[20:23], s4 offen sc1
    s_add_u32 s4, s7, 6356992
    buffer_store_dwordx4 v[196:199], v248, s[20:23], s4 offen sc1
    s_add_u32 s4, s7, 6358016
    buffer_store_dwordx4 v[200:203], v248, s[20:23], s4 offen sc1
    s_add_u32 s4, s7, 6359040
    buffer_store_dwordx4 v[204:207], v248, s[20:23], s4 offen sc1
    s_add_u32 s4, s7, 6360064
    buffer_store_dwordx4 v[208:211], v248, s[20:23], s4 offen sc1
    s_add_u32 s4, s7, 6361088
    buffer_store_dwordx4 v[212:215], v248, s[20:23], s4 offen sc1
    ds_read_b64_tr_b16 v[176:177], v251 offset:26880
    ds_read_b64_tr_b16 v[178:179], v251 offset:32000
    ds_read_b64_tr_b16 v[180:181], v251 offset:26888
    ds_read_b64_tr_b16 v[182:183], v251 offset:32008
    ds_read_b64_tr_b16 v[184:185], v251 offset:26944
    ds_read_b64_tr_b16 v[186:187], v251 offset:32064
    ds_read_b64_tr_b16 v[188:189], v251 offset:26952
    ds_read_b64_tr_b16 v[190:191], v251 offset:32072
    ds_read_b64_tr_b16 v[192:193], v249 offset:27008
    ds_read_b64_tr_b16 v[194:195], v249 offset:32128
    ds_read_b64_tr_b16 v[196:197], v251 offset:27520
    ds_read_b64_tr_b16 v[198:199], v251 offset:32640
    ds_read_b64_tr_b16 v[200:201], v251 offset:27528
    ds_read_b64_tr_b16 v[202:203], v251 offset:32648
    ds_read_b64_tr_b16 v[204:205], v251 offset:27584
    ds_read_b64_tr_b16 v[206:207], v251 offset:32704
    ds_read_b64_tr_b16 v[208:209], v251 offset:27592
    ds_read_b64_tr_b16 v[210:211], v251 offset:32712
    ds_read_b64_tr_b16 v[212:213], v249 offset:27648
    ds_read_b64_tr_b16 v[214:215], v249 offset:32768
    s_lshr_b32 s4, s6, 2
    s_mul_i32 s7, s4, 5120
    s_and_b32 s4, s6, 3
    s_lshl_b32 s4, s4, 8
    s_add_u32 s7, s7, s4
    s_add_u32 s6, s6, 1
    s_waitcnt lgkmcnt(0)
    s_add_u32 s4, s7, 5373952
    buffer_store_dwordx4 v[176:179], v248, s[20:23], s4 offen sc1
    s_add_u32 s4, s7, 5374976
    buffer_store_dwordx4 v[180:183], v248, s[20:23], s4 offen sc1
    s_add_u32 s4, s7, 5376000
    buffer_store_dwordx4 v[184:187], v248, s[20:23], s4 offen sc1
    s_add_u32 s4, s7, 5377024
    buffer_store_dwordx4 v[188:191], v248, s[20:23], s4 offen sc1
    s_add_u32 s4, s7, 5378048
    buffer_store_dwordx4 v[192:195], v248, s[20:23], s4 offen sc1
    s_add_u32 s4, s7, 6356992
    buffer_store_dwordx4 v[196:199], v248, s[20:23], s4 offen sc1
    s_add_u32 s4, s7, 6358016
    buffer_store_dwordx4 v[200:203], v248, s[20:23], s4 offen sc1
    s_add_u32 s4, s7, 6359040
    buffer_store_dwordx4 v[204:207], v248, s[20:23], s4 offen sc1
    s_add_u32 s4, s7, 6360064
    buffer_store_dwordx4 v[208:211], v248, s[20:23], s4 offen sc1
    s_add_u32 s4, s7, 6361088
    buffer_store_dwordx4 v[212:215], v248, s[20:23], s4 offen sc1
    v_mov_b32 v250, 163200
    v_mov_b32 v249, 1
    s_mov_b64 exec, 1
    ds_write_b32 v250, v249 offset:416
    s_mov_b64 exec, -1
    v_mov_b32 v252, 0
    s_mov_b32 s5, 0
Lwi69:
    buffer_load_dword v253, v252, s[24:27], 0 offen sc1
    s_add_u32 s5, s5, 1
    s_waitcnt vmcnt(0)
    v_readfirstlane_b32 s4, v253
    s_cmp_ge_u32 s4, 64
    s_cbranch_scc1 Lwie70
    s_sleep 4
    s_cmp_lt_u32 s5, 1048576
    s_cbranch_scc1 Lwi69
Lwie70:
    s_mov_b32 s6, 146
    s_lshl_b32 s4, s6, 7
    v_mov_b32 v252, s4
    v_mov_b32 v253, 1
    s_mov_b64 exec, 1
    buffer_atomic_add v253, v252, s[20:23], 0 offen sc0 sc1
    s_mov_b64 exec, -1
    v_add_u32 v252, 190, v0
    v_lshlrev_b32 v252, 7, v252
    v_mov_b32 v254, 1
    s_waitcnt vmcnt(0)
    v_readfirstlane_b32 s4, v253
    s_cmp_lg_u32 s4, 63
    s_cbranch_scc1 Lsl71
    s_mov_b64 exec, 255
    buffer_store_dword v254, v252, s[20:23], 0 offen sc1
    s_mov_b64 exec, -1
Lsl71:
    s_setprio 1
    s_branch LWjr
LSa:
    v_mov_b32 v4, 1
    v_lshl_add_u32 v5, s3, 2, v15
    s_mov_b64 exec, 1
    ds_write_b32 v5, v4 offset:448
    s_mov_b64 exec, -1
    s_mov_b32 s33, s32
    s_mov_b32 s18, s29
    s_mov_b32 s30, 0
    s_setprio 1
    s_branch LSround
LSy:
    s_setprio 3
    s_mul_i32 s7, s66, 24
    s_add_u32 s7, s7, s35
    s_lshl_b32 s6, s7, 12
    s_add_u32 s6, s6, 13631488
    v_lshlrev_b32 v4, 4, v0
    v_add_u32 v8, s33, v4
    v_add_u32 v5, 6144, v8
    v_lshl_add_u32 v9, s3, 2, v15
    v_mov_b32 v252, 0
    buffer_load_dword v253, v252, s[24:27], 0 offen sc1
    s_mov_b32 s5, 0
Lls74:
    ds_read_b32 v7, v9 offset:464
    s_add_u32 s5, s5, 1
    s_waitcnt lgkmcnt(0)
    v_readfirstlane_b32 s4, v7
    s_cmp_ge_u32 s4, 1
    s_cbranch_scc1 Llse75
    s_sleep 1
    s_cmp_lt_u32 s5, 1048576
    s_cbranch_scc1 Lls74
Llse75:
    ds_read_b128 v[96:99], v8 offset:0
    ds_read_b128 v[100:103], v8 offset:1024
    ds_read_b128 v[104:107], v5 offset:0
    ds_read_b128 v[108:111], v5 offset:1024
    v_mov_b32 v6, 1
    v_mov_b32 v7, 0
    s_waitcnt lgkmcnt(0)
    buffer_store_dwordx4 v[96:99], v4, s[20:23], s6 offen offset:0 sc1
    s_mov_b64 exec, 0xffffff
    buffer_store_dwordx4 v[100:103], v4, s[20:23], s6 offen offset:1024 sc1
    s_mov_b64 exec, -1
    buffer_store_dwordx4 v[104:107], v4, s[20:23], s6 offen offset:2048 sc1
    s_mov_b64 exec, 0xffffff
    buffer_store_dwordx4 v[108:111], v4, s[20:23], s6 offen offset:3072 sc1
    s_mov_b64 exec, -1
    s_mov_b64 exec, 1
    ds_add_u32 v15, v6 offset:464
    s_mov_b64 exec, -1
    s_mov_b64 exec, 1
    ds_write_b32 v9, v7 offset:320
    s_mov_b64 exec, -1
    s_waitcnt vmcnt(0)
    v_readfirstlane_b32 s4, v253
    s_cmp_lt_u32 s4, 64
    s_cbranch_scc1 Lisl77
Liok76:
    s_add_u32 s4, s7, 264
    s_lshl_b32 s4, s4, 7
    v_mov_b32 v7, s4
    s_mov_b64 exec, 1
    buffer_store_dword v6, v7, s[20:23], 0 offen sc1
    s_mov_b64 exec, -1
    s_mov_b64 exec, 1
    ds_add_u32 v15, v6 offset:408
    s_mov_b64 exec, -1
    s_branch LS2G
LCx:
    v_lshl_add_u32 v15, s29, 4, v15
    v_mov_b32 v4, 1
    s_mov_b64 exec, 1
    ds_add_u32 v15, v4 offset:432
    s_mov_b64 exec, -1
    v_lshl_add_u32 v8, v0, 4, s33
    s_lshl_b32 s4, s35, 11
    v_subrev_u32 v5, s4, v5
    s_add_u32 s7, s7, s4
    ds_read_b64 v[48:49], v5 offset:3584
    ds_read_b64 v[50:51], v5 offset:3072
    ds_read_b64 v[52:53], v5 offset:2560
    ds_read_b64 v[54:55], v5 offset:2048
    s_mov_b32 s5, 0
Lls86:
    ds_read_b32 v84, v15 offset:432
    s_add_u32 s5, s5, 1
    s_waitcnt lgkmcnt(0)
    v_readfirstlane_b32 s4, v84
    s_cmp_ge_u32 s4, 2
    s_cbranch_scc1 Llse87
    s_sleep 0
    s_cmp_lt_u32 s5, 1048576
    s_cbranch_scc1 Lls86
Llse87:
    s_cmp_eq_u32 s35, 0
    s_cbranch_scc1 LCx0
    ds_write_b128 v8, v[16:19] offset:0
    ds_write_b128 v8, v[20:23] offset:1024
    ds_write_b128 v8, v[24:27] offset:2048
    ds_write_b128 v8, v[28:31] offset:3072
    v_mov_b32 v88, v32
    v_mov_b32 v89, v33
    v_mov_b32 v90, v34
    v_mov_b32 v91, v35
    v_mov_b32 v92, v36
    v_mov_b32 v93, v37
    v_mov_b32 v94, v38
    v_mov_b32 v95, v39
    v_mov_b32 v96, v40
    v_mov_b32 v97, v41
    v_mov_b32 v98, v42
    v_mov_b32 v99, v43
    v_mov_b32 v100, v44
    v_mov_b32 v101, v45
    v_mov_b32 v102, v46
    v_mov_b32 v103, v47
    s_branch LCx1
LCx0:
    ds_write_b128 v8, v[32:35] offset:4096
    ds_write_b128 v8, v[36:39] offset:5120
    ds_write_b128 v8, v[40:43] offset:6144
    ds_write_b128 v8, v[44:47] offset:7168
    v_mov_b32 v88, v16
    v_mov_b32 v89, v17
    v_mov_b32 v90, v18
    v_mov_b32 v91, v19
    v_mov_b32 v92, v20
    v_mov_b32 v93, v21
    v_mov_b32 v94, v22
    v_mov_b32 v95, v23
    v_mov_b32 v96, v24
    v_mov_b32 v97, v25
    v_mov_b32 v98, v26
    v_mov_b32 v99, v27
    v_mov_b32 v100, v28
    v_mov_b32 v101, v29
    v_mov_b32 v102, v30
    v_mov_b32 v103, v31
LCx1:
    s_mov_b64 exec, 1
    ds_add_u32 v15, v4 offset:436
    s_mov_b64 exec, -1
    s_lshl_b32 s4, s35, 12
    v_add_u32 v8, s4, v8
    s_mov_b32 s5, 0
Lls88:
    ds_read_b32 v84, v15 offset:436
    s_add_u32 s5, s5, 1
    s_waitcnt lgkmcnt(0)
    v_readfirstlane_b32 s4, v84
    s_cmp_ge_u32 s4, 2
    s_cbranch_scc1 Llse89
    s_sleep 0
    s_cmp_lt_u32 s5, 1048576
    s_cbranch_scc1 Lls88
Llse89:
    ds_read_b128 v[104:107], v8 offset:0
    ds_read_b128 v[108:111], v8 offset:1024
    ds_read_b128 v[112:115], v8 offset:2048
    ds_read_b128 v[116:119], v8 offset:3072
    s_waitcnt lgkmcnt(0)
    v_add_f32 v88, v88, v104
    v_add_f32 v89, v89, v105
    v_add_f32 v90, v90, v106
    v_add_f32 v91, v91, v107
    v_add_f32 v92, v92, v108
    v_add_f32 v93, v93, v109
    v_add_f32 v94, v94, v110
    v_add_f32 v95, v95, v111
    v_add_f32 v96, v96, v112
    v_add_f32 v97, v97, v113
    v_add_f32 v98, v98, v114
    v_add_f32 v99, v99, v115
    v_add_f32 v100, v100, v116
    v_add_f32 v101, v101, v117
    v_add_f32 v102, v102, v118
    v_add_f32 v103, v103, v119
    v_and_b32 v80, 0xffff0000, v49
    v_lshlrev_b32 v81, 16, v49
    v_and_b32 v82, 0xffff0000, v48
    v_lshlrev_b32 v83, 16, v48
    v_fmac_f32 v88, s17, v80
    v_fmac_f32 v89, s17, v81
    v_fmac_f32 v90, s17, v82
    v_fmac_f32_e64 v91, s17, v83
    v_cvt_pk_bf16_f32 v64, v88, v89
    v_cvt_pk_bf16_f32 v65, v90, v91
    v_and_b32 v80, 0xffff0000, v51
    v_lshlrev_b32 v81, 16, v51
    v_and_b32 v82, 0xffff0000, v50
    v_lshlrev_b32 v83, 16, v50
    v_fmac_f32 v92, s17, v80
    v_fmac_f32 v93, s17, v81
    v_fmac_f32 v94, s17, v82
    v_fmac_f32 v95, s17, v83
    v_cvt_pk_bf16_f32 v66, v92, v93
    v_cvt_pk_bf16_f32 v67, v94, v95
    s_nop 0
    v_permlane16_swap_b32 v64, v66
    v_permlane16_swap_b32 v65, v67
    buffer_store_dwordx4 v[64:67], v6, s[20:23], s7 offen offset:0 sc1
    v_and_b32 v80, 0xffff0000, v53
    v_lshlrev_b32 v81, 16, v53
    v_and_b32 v82, 0xffff0000, v52
    v_lshlrev_b32 v83, 16, v52
    v_fmac_f32 v96, s17, v80
    v_fmac_f32 v97, s17, v81
    v_fmac_f32 v98, s17, v82
    v_fmac_f32_e64 v99, s17, v83
    v_cvt_pk_bf16_f32 v68, v96, v97
    v_cvt_pk_bf16_f32 v69, v98, v99
    v_and_b32 v80, 0xffff0000, v55
    v_lshlrev_b32 v81, 16, v55
    v_and_b32 v82, 0xffff0000, v54
    v_lshlrev_b32 v83, 16, v54
    v_fmac_f32 v100, s17, v80
    v_fmac_f32 v101, s17, v81
    v_fmac_f32 v102, s17, v82
    v_fmac_f32 v103, s17, v83
    v_cvt_pk_bf16_f32 v70, v100, v101
    v_cvt_pk_bf16_f32 v71, v102, v103
    s_nop 0
    v_permlane16_swap_b32 v68, v70
    v_permlane16_swap_b32 v69, v71
    buffer_store_dwordx4 v[68:71], v6, s[20:23], s7 offen offset:1024 sc1
    s_setprio 0
    s_waitcnt vmcnt(0)
    s_mov_b64 exec, 1
    ds_add_rtn_u32 v7, v15, v4 offset:440
    s_mov_b64 exec, -1
    s_add_u32 s6, s66, 128
    s_waitcnt lgkmcnt(0)
    v_readfirstlane_b32 s4, v7
    s_cmp_eq_u32 s4, 1
    s_cbranch_scc1 LCsig
    s_branch LCdone
Lisl27:
    v_mov_b32 v12, 0
    s_mov_b32 s5, 0
Lwi28:
    buffer_load_dword v13, v12, s[24:27], 0 offen sc1
    s_add_u32 s5, s5, 1
    s_waitcnt vmcnt(0)
    v_readfirstlane_b32 s4, v13
    s_cmp_ge_u32 s4, 64
    s_cbranch_scc1 Lwie29
    s_sleep 4
    s_cmp_lt_u32 s5, 1048576
    s_cbranch_scc1 Lwi28
Lwie29:
    s_branch Liok26
Lisl77:
    v_mov_b32 v252, 0
    s_mov_b32 s5, 0
Lwi78:
    buffer_load_dword v253, v252, s[24:27], 0 offen sc1
    s_add_u32 s5, s5, 1
    s_waitcnt vmcnt(0)
    v_readfirstlane_b32 s4, v253
    s_cmp_ge_u32 s4, 64
    s_cbranch_scc1 Lwie79
    s_sleep 4
    s_cmp_lt_u32 s5, 1048576
    s_cbranch_scc1 Lwi78
Lwie79:
    s_branch Liok76
Lend:
    s_endpgm
.section .rodata,"a"
.p2align 6
.amdhsa_kernel gated_mix__ssm_conv_s4d__swiglu_ffn__prompt_kernel
  .amdhsa_next_free_vgpr 256
  .amdhsa_next_free_sgpr 102
  .amdhsa_accum_offset 256
  .amdhsa_group_segment_fixed_size 0
  .amdhsa_kernarg_size 120
  .amdhsa_user_sgpr_count 2
  .amdhsa_user_sgpr_kernarg_segment_ptr 1
  .amdhsa_system_sgpr_workgroup_id_x 1
  .amdhsa_float_denorm_mode_32 3
.end_amdhsa_kernel
```
